```python
import torch

def _softmax(x, axis=-1):
    return torch.softmax(x, dim=axis)
def _gelu(x):
    return torch.nn.functional.gelu(x, approximate="tanh")
def _silu(x):
    return torch.nn.functional.silu(x)
def _sigmoid(x):
    return torch.sigmoid(x)
def _layernorm(x, axis=-1, eps=1e-5):
    m = x.mean(dim=axis, keepdim=True)
    v = x.var(dim=axis, keepdim=True, unbiased=False)
    return (x - m) / torch.sqrt(v + eps)
def _scatter_add(tgt, idx, src, axis=0):
    return tgt.clone().index_add_(axis, idx, src)
def _segment_sum(src, seg, n):
    out = torch.zeros((n,) + src.shape[1:], dtype=src.dtype)
    return out.index_add_(0, seg, src)
def _pad(x, pw):
    flat = tuple(v for pair in reversed(pw) for v in pair)
    return torch.nn.functional.pad(x, flat)

kernel_name = 'parallel_sum__ssm_conv_s4__dense_activation_mish__prompt'

def setup_inputs():

    _w = (lambda a: (lambda t: t.to(torch.bfloat16) if t.is_floating_point() else t)(torch.as_tensor(a)))
    def _A_setup():
        B, L, D, N = 1, 2048, 512, 128
        A_re = -(lambda _x: torch.exp(torch.as_tensor(_x)))((lambda *s: torch.randn(*s, dtype=torch.bfloat16) * 6.4)(D, N))
        A_im = torch.pi * (lambda *s: torch.randn(*s, dtype=torch.bfloat16) * 0.05)(D, N)
        B_re = (lambda *s: torch.randn(*s, dtype=torch.bfloat16) * 0.1)(D, N)
        B_im = (lambda *s: torch.randn(*s, dtype=torch.bfloat16) * 0.1)(D, N)
        C_re = (lambda *s: torch.randn(*s, dtype=torch.bfloat16) * 0.1)(D, N)
        C_im = (lambda *s: torch.randn(*s, dtype=torch.bfloat16) * 0.1)(D, N)
        log_dt = (lambda *s: torch.randn(*s, dtype=torch.bfloat16) * 0.05)(D) * 0.5 - 4.0
        Dskip = (lambda *s: torch.randn(*s, dtype=torch.bfloat16) * 0.05)(D)
        return {
            "u": _w((lambda *s: torch.randn(*s, dtype=torch.bfloat16) * 0.05)(B, L, D)),
            "A_re": _w(A_re),
            "A_im": _w(A_im),
            "B_re": _w(B_re),
            "B_im": _w(B_im),
            "C_re": _w(C_re),
            "C_im": _w(C_im),
            "log_dt": _w(log_dt),
            "Dskip": _w(Dskip),
        }
    _A_in = _A_setup()

    def _B_setup():
        B, S, D, F = 1, 2048, 512, 1792
        return {
            "x": _w((lambda *s: torch.randn(*s, dtype=torch.bfloat16) * 0.05)(B, S, D)),
            "w1": _w((lambda *s: torch.randn(*s, dtype=torch.bfloat16) * 0.8)(D, F) * (D ** -0.5)),
            "b1": _w((lambda *s: torch.randn(*s, dtype=torch.bfloat16) * 0.2)(F)),
            "w2": _w((lambda *s: torch.randn(*s, dtype=torch.bfloat16) * 0.2)(F, D) * (F ** -0.5)),
        }
    _B_in = _B_setup()

    return {
        "A_u": _A_in["u"],
        "A_A_re": _A_in["A_re"],
        "A_A_im": _A_in["A_im"],
        "A_B_re": _A_in["B_re"],
        "A_B_im": _A_in["B_im"],
        "A_C_re": _A_in["C_re"],
        "A_C_im": _A_in["C_im"],
        "A_log_dt": _A_in["log_dt"],
        "A_Dskip": _A_in["Dskip"],
        "B_x": _B_in["x"],
        "B_w1": _B_in["w1"],
        "B_b1": _B_in["b1"],
        "B_w2": _B_in["w2"],
    }

def reference(A_u, A_A_re, A_A_im, A_B_re, A_B_im, A_C_re, A_C_im, A_log_dt, A_Dskip, B_x, B_w1, B_b1, B_w2):
    def _A_ref(u, A_re, A_im, B_re, B_im, C_re, C_im, log_dt, Dskip):
        Bsz, L, D = u.shape
        dt = torch.exp(log_dt)[:, None]
        A = A_re + 1j * A_im
        Bc = B_re + 1j * B_im
        Cc = C_re + 1j * C_im
        logdA = dt * A
        dB = dt * Bc
        l = (lambda x, dt: x.to(dt))(torch.arange(L), A_re.dtype)
        P = torch.exp(logdA[:, :, None] * l[None, None, :])
        K = torch.einsum("dn,dnl,dn->dl", Cc, P, dB).real
        L2 = 2 * L
        Kp = _pad(K, ((0, 0), (0, L)))
        up = (lambda x, *d: x.permute(*d))(u, 0, 2, 1)
        up = _pad(up, ((0, 0), (0, 0), (0, L)))
        Kf = (lambda x, axes=(-2,-1): torch.fft.rfft2(x.float(), dim=axes))(Kp[:, None, :], axes=(-2, -1))
        Uf = (lambda x, axes=(-2,-1): torch.fft.rfft2(x.float(), dim=axes))(up[:, :, None, :], axes=(-2, -1))
        Yf = Uf * Kf[None, :, :, :]
        y = (lambda x, s, axes=(-2,-1): torch.fft.irfft2(x, s=s, dim=axes).to(torch.bfloat16))(Yf, (1, L2), axes=(-2, -1))[:, :, 0, :L]
        y = (lambda x, *d: x.permute(*d))(y, 0, 2, 1) + u * Dskip[None, None, :]
        return y

    def _B_ref(x, w1, b1, w2):
        h = torch.einsum("bsd,df->bsf", x, w1) + b1
        sp = torch.log1p(torch.exp(-torch.abs(h))) + torch.where(h > 0, h, torch.zeros_like(h))
        act = h * torch.tanh(sp)
        return torch.einsum("bsf,fd->bsd", act, w2)

    x = A_u
    xn = _layernorm(x, axis=-1)
    return x + _A_ref(xn, A_A_re, A_A_im, A_B_re, A_B_im, A_C_re, A_C_im, A_log_dt, A_Dskip) + _B_ref(xn, B_w1, B_b1, B_w2)
```

```asm
; @launch grid=(512,1,1) block=(256,1,1) lds=74240
.amdgcn_target "amdgcn-amd-amdhsa--gfx950"
.text
.globl parallel_sum__ssm_conv_s4__dense_activation_mish__prompt_kernel
.p2align 8
.type parallel_sum__ssm_conv_s4__dense_activation_mish__prompt_kernel,@function
parallel_sum__ssm_conv_s4__dense_activation_mish__prompt_kernel:
    s_cmp_ge_u32 s2, 512
    s_cbranch_scc1 L_done
    s_lshr_b32 s3, s2, 8
    s_lshr_b32 s4, s2, 3
    s_xor_b32 s3, s3, s4
    s_and_b32 s3, s3, 1
    s_lshl_b32 s3, s3, 8
    s_and_b32 s2, s2, 0xff
    s_or_b32 s2, s2, s3
    s_load_dwordx2 s[6:7], s[0:1], 0
    s_load_dwordx2 s[4:5], s[0:1], 120
    s_load_dwordx4 s[64:67], s[0:1], 8
    s_load_dwordx4 s[68:71], s[0:1], 24
    s_load_dwordx4 s[72:75], s[0:1], 40
    s_load_dwordx4 s[76:79], s[0:1], 56
    s_load_dwordx4 s[56:59], s[0:1], 80
    s_load_dwordx4 s[60:63], s[0:1], 96
    s_load_dwordx2 s[20:21], s[0:1], 112
    v_and_b32 v1, 63, v0
    v_lshrrev_b32 v2, 6, v0
    s_nop 0
    v_readfirstlane_b32 s22, v2
    v_lshrrev_b32 v3, 4, v1
    v_and_b32 v4, 15, v1
    v_mov_b32 v250, 0
    v_mov_b32 v251, 1
    s_cmp_ge_u32 s2, 256
    s_cbranch_scc1 L_roleS
    s_setprio 2
    s_lshl_b32 s50, s2, 3
    s_lshl_b32 s51, s22, 1
    s_add_u32 s50, s50, s51
    s_lshl_b32 s50, s50, 10
    v_lshlrev_b32 v5, 4, v1
    v_add_u32 v6, s50, v5
    s_waitcnt lgkmcnt(0)
    s_add_u32 s18, s4, 25165824
    s_addc_u32 s19, s5, 0
    global_load_dwordx4 v[16:19], v6, s[6:7]
    global_load_dwordx4 v[20:23], v6, s[6:7] offset:1024
    s_mov_b32 s8, s56
    s_mov_b32 s9, s57
    s_mov_b32 s10, 1835008
    s_mov_b32 s11, 0x00020000
    s_mov_b32 s12, s4
    s_mov_b32 s13, s5
    s_mov_b32 s14, 0x10000000
    s_mov_b32 s15, 0x00020000
    s_and_b32 s26, s2, 3
    s_lshl_b32 s26, s26, 2
    s_bfe_u32 s27, s2, 0x20003
    s_add_u32 s26, s26, s27
    s_bfe_u32 s27, s2, 0x10002
    s_lshl_b32 s27, s27, 3
    s_lshr_b32 s50, s2, 5
    s_add_u32 s27, s27, s50
    s_lshl_b32 s28, s26, 3
    s_lshl_b32 s50, s22, 1
    s_add_u32 s28, s28, s50
    s_lshr_b32 s50, s2, 3
    s_lshr_b32 s51, s2, 5
    s_add_u32 s50, s50, s51
    s_lshl_b32 s50, s50, 1
    s_add_u32 s51, s50, 0
    s_and_b32 s51, s51, 7
    s_mul_i32 s34, s51, 57344
    s_lshl_b32 s68, s51, 11
    s_add_u32 s51, s50, 1
    s_and_b32 s51, s51, 7
    s_mul_i32 s35, s51, 57344
    s_lshl_b32 s69, s51, 11
    s_add_u32 s51, s50, 2
    s_and_b32 s51, s51, 7
    s_mul_i32 s36, s51, 57344
    s_lshl_b32 s70, s51, 11
    s_add_u32 s51, s50, 3
    s_and_b32 s51, s51, 7
    s_mul_i32 s37, s51, 57344
    s_lshl_b32 s71, s51, 11
    s_add_u32 s51, s50, 4
    s_and_b32 s51, s51, 7
    s_mul_i32 s38, s51, 57344
    s_lshl_b32 s72, s51, 11
    s_add_u32 s51, s50, 5
    s_and_b32 s51, s51, 7
    s_mul_i32 s39, s51, 57344
    s_lshl_b32 s73, s51, 11
    s_add_u32 s51, s50, 6
    s_and_b32 s51, s51, 7
    s_mul_i32 s40, s51, 57344
    s_lshl_b32 s74, s51, 11
    s_add_u32 s51, s50, 7
    s_and_b32 s51, s51, 7
    s_mul_i32 s41, s51, 57344
    s_lshl_b32 s75, s51, 11
    s_mul_i32 s50, s27, 224
    s_mul_i32 s51, s22, 458752
    s_add_u32 s51, s51, s50
    v_add_u32 v7, 0, v1
    v_mul_u32_u24 v8, 4682, v7
    v_lshrrev_b32 v8, 16, v8
    v_mul_u32_u24 v9, 14, v8
    v_sub_u32 v9, v7, v9
    v_mul_u32_u24 v8, 3584, v8
    v_lshl_add_u32 v8, v9, 4, v8
    v_add_u32 v200, s51, v8
    v_add_u32 v7, 64, v1
    v_mul_u32_u24 v8, 4682, v7
    v_lshrrev_b32 v8, 16, v8
    v_mul_u32_u24 v9, 14, v8
    v_sub_u32 v9, v7, v9
    v_mul_u32_u24 v8, 3584, v8
    v_lshl_add_u32 v8, v9, 4, v8
    v_add_u32 v201, s51, v8
    v_add_u32 v7, 128, v1
    v_mul_u32_u24 v8, 4682, v7
    v_lshrrev_b32 v8, 16, v8
    v_mul_u32_u24 v9, 14, v8
    v_sub_u32 v9, v7, v9
    v_mul_u32_u24 v8, 3584, v8
    v_lshl_add_u32 v8, v9, 4, v8
    v_add_u32 v202, s51, v8
    v_add_u32 v7, 192, v1
    v_mul_u32_u24 v8, 4682, v7
    v_lshrrev_b32 v8, 16, v8
    v_mul_u32_u24 v9, 14, v8
    v_sub_u32 v9, v7, v9
    v_mul_u32_u24 v8, 3584, v8
    v_lshl_add_u32 v8, v9, 4, v8
    v_add_u32 v203, s51, v8
    s_mul_i32 s43, s22, 3712
    v_lshlrev_b32 v8, 3, v3
    v_add_u32 v253, s50, v8
    s_add_u32 s50, s43, 0
    s_mov_b32 m0, s50
    s_nop 0
    buffer_load_dwordx4 v200, s[8:11], s34 offen lds
    s_add_u32 s50, s43, 1024
    s_mov_b32 m0, s50
    s_nop 0
    buffer_load_dwordx4 v201, s[8:11], s34 offen lds
    s_add_u32 s50, s43, 2048
    s_mov_b32 m0, s50
    s_nop 0
    buffer_load_dwordx4 v202, s[8:11], s34 offen lds
    s_add_u32 s50, s43, 3072
    s_mov_b32 m0, s50
    s_mov_b64 exec, 0xffffffff
    buffer_load_dwordx4 v203, s[8:11], s34 offen lds
    s_mov_b64 exec, -1
    s_add_u32 s50, s43, 14848
    s_mov_b32 m0, s50
    s_nop 0
    buffer_load_dwordx4 v200, s[8:11], s35 offen lds
    s_add_u32 s50, s43, 15872
    s_mov_b32 m0, s50
    s_nop 0
    buffer_load_dwordx4 v201, s[8:11], s35 offen lds
    s_add_u32 s50, s43, 16896
    s_mov_b32 m0, s50
    s_nop 0
    buffer_load_dwordx4 v202, s[8:11], s35 offen lds
    s_add_u32 s50, s43, 17920
    s_mov_b32 m0, s50
    s_mov_b64 exec, 0xffffffff
    buffer_load_dwordx4 v203, s[8:11], s35 offen lds
    s_mov_b64 exec, -1
    s_add_u32 s50, s43, 29696
    s_mov_b32 m0, s50
    s_nop 0
    buffer_load_dwordx4 v200, s[8:11], s36 offen lds
    s_add_u32 s50, s43, 30720
    s_mov_b32 m0, s50
    s_nop 0
    buffer_load_dwordx4 v201, s[8:11], s36 offen lds
    s_add_u32 s50, s43, 31744
    s_mov_b32 m0, s50
    s_nop 0
    buffer_load_dwordx4 v202, s[8:11], s36 offen lds
    s_add_u32 s50, s43, 32768
    s_mov_b32 m0, s50
    s_mov_b64 exec, 0xffffffff
    buffer_load_dwordx4 v203, s[8:11], s36 offen lds
    s_mov_b64 exec, -1
    s_add_u32 s50, s43, 44544
    s_mov_b32 m0, s50
    s_nop 0
    buffer_load_dwordx4 v200, s[8:11], s37 offen lds
    s_add_u32 s50, s43, 45568
    s_mov_b32 m0, s50
    s_nop 0
    buffer_load_dwordx4 v201, s[8:11], s37 offen lds
    s_add_u32 s50, s43, 46592
    s_mov_b32 m0, s50
    s_nop 0
    buffer_load_dwordx4 v202, s[8:11], s37 offen lds
    s_add_u32 s50, s43, 47616
    s_mov_b32 m0, s50
    s_mov_b64 exec, 0xffffffff
    buffer_load_dwordx4 v203, s[8:11], s37 offen lds
    s_mov_b64 exec, -1
    s_waitcnt vmcnt(16)
    v_lshlrev_b32 v60, 16, v16
    v_and_b32 v61, 0xffff0000, v16
    v_lshlrev_b32 v62, 16, v17
    v_and_b32 v63, 0xffff0000, v17
    v_lshlrev_b32 v64, 16, v18
    v_and_b32 v65, 0xffff0000, v18
    v_lshlrev_b32 v66, 16, v19
    v_and_b32 v67, 0xffff0000, v19
    v_lshlrev_b32 v80, 16, v20
    v_and_b32 v81, 0xffff0000, v20
    v_lshlrev_b32 v82, 16, v21
    v_and_b32 v83, 0xffff0000, v21
    v_lshlrev_b32 v84, 16, v22
    v_and_b32 v85, 0xffff0000, v22
    v_lshlrev_b32 v86, 16, v23
    v_and_b32 v87, 0xffff0000, v23
    v_add_f32 v44, v60, v61
    v_add_f32 v45, v62, v63
    v_add_f32 v46, v64, v65
    v_add_f32 v47, v66, v67
    v_add_f32 v48, v80, v81
    v_add_f32 v49, v82, v83
    v_add_f32 v50, v84, v85
    v_add_f32 v51, v86, v87
    v_add_f32 v44, v44, v45
    v_add_f32 v46, v46, v47
    v_add_f32 v48, v48, v49
    v_add_f32 v50, v50, v51
    v_add_f32 v44, v44, v46
    v_add_f32 v48, v48, v50
    s_nop 0
    v_add_f32_dpp v44, v44, v44 row_ror:1 row_mask:0xf bank_mask:0xf
    v_add_f32_dpp v48, v48, v48 row_ror:1 row_mask:0xf bank_mask:0xf
    s_nop 0
    v_add_f32_dpp v44, v44, v44 row_ror:2 row_mask:0xf bank_mask:0xf
    v_add_f32_dpp v48, v48, v48 row_ror:2 row_mask:0xf bank_mask:0xf
    s_nop 0
    v_add_f32_dpp v44, v44, v44 row_ror:4 row_mask:0xf bank_mask:0xf
    v_add_f32_dpp v48, v48, v48 row_ror:4 row_mask:0xf bank_mask:0xf
    s_nop 0
    v_add_f32_dpp v44, v44, v44 row_ror:8 row_mask:0xf bank_mask:0xf
    v_add_f32_dpp v48, v48, v48 row_ror:8 row_mask:0xf bank_mask:0xf
    v_mov_b32 v45, v44
    v_mov_b32 v49, v48
    s_nop 0
    v_permlane16_swap_b32 v44, v45
    v_permlane16_swap_b32 v48, v49
    v_add_f32 v44, v44, v45
    v_add_f32 v48, v48, v49
    v_mov_b32 v45, v44
    v_mov_b32 v49, v48
    s_nop 0
    v_permlane32_swap_b32 v44, v45
    v_permlane32_swap_b32 v48, v49
    v_add_f32 v44, v44, v45
    v_add_f32 v48, v48, v49
    v_mul_f32 v44, 0x3b000000, v44
    v_mul_f32 v48, 0x3b000000, v48
    v_sub_f32 v68, v60, v44
    v_sub_f32 v69, v61, v44
    v_sub_f32 v70, v62, v44
    v_sub_f32 v71, v63, v44
    v_sub_f32 v72, v64, v44
    v_sub_f32 v73, v65, v44
    v_sub_f32 v74, v66, v44
    v_sub_f32 v75, v67, v44
    v_sub_f32 v88, v80, v48
    v_sub_f32 v89, v81, v48
    v_sub_f32 v90, v82, v48
    v_sub_f32 v91, v83, v48
    v_sub_f32 v92, v84, v48
    v_sub_f32 v93, v85, v48
    v_sub_f32 v94, v86, v48
    v_sub_f32 v95, v87, v48
    v_mul_f32 v46, v68, v68
    v_mul_f32 v47, v69, v69
    v_mul_f32 v50, v88, v88
    v_mul_f32 v51, v89, v89
    v_fmac_f32 v46, v70, v70
    v_fmac_f32 v50, v90, v90
    v_fmac_f32 v47, v71, v71
    v_fmac_f32 v51, v91, v91
    v_fmac_f32 v46, v72, v72
    v_fmac_f32 v50, v92, v92
    v_fmac_f32 v47, v73, v73
    v_fmac_f32 v51, v93, v93
    v_fmac_f32 v46, v74, v74
    v_fmac_f32 v50, v94, v94
    v_fmac_f32 v47, v75, v75
    v_fmac_f32 v51, v95, v95
    v_add_f32 v46, v46, v47
    v_add_f32 v50, v50, v51
    s_nop 0
    v_add_f32_dpp v46, v46, v46 row_ror:1 row_mask:0xf bank_mask:0xf
    v_add_f32_dpp v50, v50, v50 row_ror:1 row_mask:0xf bank_mask:0xf
    s_nop 0
    v_add_f32_dpp v46, v46, v46 row_ror:2 row_mask:0xf bank_mask:0xf
    v_add_f32_dpp v50, v50, v50 row_ror:2 row_mask:0xf bank_mask:0xf
    s_nop 0
    v_add_f32_dpp v46, v46, v46 row_ror:4 row_mask:0xf bank_mask:0xf
    v_add_f32_dpp v50, v50, v50 row_ror:4 row_mask:0xf bank_mask:0xf
    s_nop 0
    v_add_f32_dpp v46, v46, v46 row_ror:8 row_mask:0xf bank_mask:0xf
    v_add_f32_dpp v50, v50, v50 row_ror:8 row_mask:0xf bank_mask:0xf
    v_mov_b32 v45, v46
    v_mov_b32 v49, v50
    s_nop 0
    v_permlane16_swap_b32 v46, v45
    v_permlane16_swap_b32 v50, v49
    v_add_f32 v46, v46, v45
    v_add_f32 v50, v50, v49
    v_mov_b32 v45, v46
    v_mov_b32 v49, v50
    s_nop 0
    v_permlane32_swap_b32 v46, v45
    v_permlane32_swap_b32 v50, v49
    v_add_f32 v46, v46, v45
    v_add_f32 v50, v50, v49
    v_mul_f32 v46, 0x3b000000, v46
    v_cvt_pk_bf16_f32 v44, v44, v44
    v_lshlrev_b32 v44, 16, v44
    v_cvt_pk_bf16_f32 v46, v46, v46
    v_lshlrev_b32 v46, 16, v46
    v_add_f32 v46, 0x3727c5ac, v46
    v_cvt_pk_bf16_f32 v46, v46, v46
    v_lshlrev_b32 v46, 16, v46
    v_sqrt_f32 v46, v46
    v_mul_f32 v50, 0x3b000000, v50
    v_cvt_pk_bf16_f32 v48, v48, v48
    v_lshlrev_b32 v48, 16, v48
    v_cvt_pk_bf16_f32 v50, v50, v50
    v_lshlrev_b32 v50, 16, v50
    v_add_f32 v50, 0x3727c5ac, v50
    v_cvt_pk_bf16_f32 v50, v50, v50
    v_lshlrev_b32 v50, 16, v50
    v_sqrt_f32 v50, v50
    v_cvt_pk_bf16_f32 v46, v46, v46
    v_lshlrev_b32 v46, 16, v46
    v_rcp_f32 v46, v46
    v_cvt_pk_bf16_f32 v50, v50, v50
    v_lshlrev_b32 v50, 16, v50
    v_rcp_f32 v50, v50
    v_sub_f32 v60, v60, v44
    v_sub_f32 v61, v61, v44
    v_cvt_pk_bf16_f32 v16, v60, v61
    v_lshlrev_b32 v60, 16, v16
    v_and_b32 v61, 0xffff0000, v16
    v_mul_f32 v60, v60, v46
    v_mul_f32 v61, v61, v46
    v_cvt_pk_bf16_f32 v16, v60, v61
    v_sub_f32 v80, v80, v48
    v_sub_f32 v81, v81, v48
    v_cvt_pk_bf16_f32 v20, v80, v81
    v_lshlrev_b32 v80, 16, v20
    v_and_b32 v81, 0xffff0000, v20
    v_mul_f32 v80, v80, v50
    v_mul_f32 v81, v81, v50
    v_cvt_pk_bf16_f32 v20, v80, v81
    v_sub_f32 v62, v62, v44
    v_sub_f32 v63, v63, v44
    v_cvt_pk_bf16_f32 v17, v62, v63
    v_lshlrev_b32 v62, 16, v17
    v_and_b32 v63, 0xffff0000, v17
    v_mul_f32 v62, v62, v46
    v_mul_f32 v63, v63, v46
    v_cvt_pk_bf16_f32 v17, v62, v63
    v_sub_f32 v82, v82, v48
    v_sub_f32 v83, v83, v48
    v_cvt_pk_bf16_f32 v21, v82, v83
    v_lshlrev_b32 v82, 16, v21
    v_and_b32 v83, 0xffff0000, v21
    v_mul_f32 v82, v82, v50
    v_mul_f32 v83, v83, v50
    v_cvt_pk_bf16_f32 v21, v82, v83
    v_sub_f32 v64, v64, v44
    v_sub_f32 v65, v65, v44
    v_cvt_pk_bf16_f32 v18, v64, v65
    v_lshlrev_b32 v64, 16, v18
    v_and_b32 v65, 0xffff0000, v18
    v_mul_f32 v64, v64, v46
    v_mul_f32 v65, v65, v46
    v_cvt_pk_bf16_f32 v18, v64, v65
    v_sub_f32 v84, v84, v48
    v_sub_f32 v85, v85, v48
    v_cvt_pk_bf16_f32 v22, v84, v85
    v_lshlrev_b32 v84, 16, v22
    v_and_b32 v85, 0xffff0000, v22
    v_mul_f32 v84, v84, v50
    v_mul_f32 v85, v85, v50
    v_cvt_pk_bf16_f32 v22, v84, v85
    v_sub_f32 v66, v66, v44
    v_sub_f32 v67, v67, v44
    v_cvt_pk_bf16_f32 v19, v66, v67
    v_lshlrev_b32 v66, 16, v19
    v_and_b32 v67, 0xffff0000, v19
    v_mul_f32 v66, v66, v46
    v_mul_f32 v67, v67, v46
    v_cvt_pk_bf16_f32 v19, v66, v67
    v_sub_f32 v86, v86, v48
    v_sub_f32 v87, v87, v48
    v_cvt_pk_bf16_f32 v23, v86, v87
    v_lshlrev_b32 v86, 16, v23
    v_and_b32 v87, 0xffff0000, v23
    v_mul_f32 v86, v86, v50
    v_mul_f32 v87, v87, v50
    v_cvt_pk_bf16_f32 v23, v86, v87
    s_mul_i32 s50, s22, 2080
    s_add_u32 s50, s50, 59392
    v_add_u32 v44, s50, v5
    ds_write_b128 v44, v[16:19]
    ds_write_b128 v44, v[20:23] offset:1040
    v_and_b32 v45, 7, v1
    v_lshrrev_b32 v46, 3, v1
    s_lshl_b32 s50, s22, 4
    v_add_u32 v46, s50, v46
    v_mul_u32_u24 v47, 1040, v45
    v_lshl_add_u32 v47, v46, 4, v47
    v_add_u32 v47, 59392, v47
    v_and_b32 v48, 15, v46
    v_lshlrev_b32 v48, 10, v48
    v_lshl_add_u32 v48, v45, 4, v48
    s_lshr_b32 s50, s2, 1
    s_lshl_b32 s50, s50, 14
    s_and_b32 s51, s2, 1
    s_lshl_b32 s51, s51, 7
    s_add_u32 s50, s50, s51
    s_lshl_b32 s51, s22, 8
    s_add_u32 s50, s50, s51
    v_add_u32 v48, s50, v48
    v_add_u32 v51, 0x2000, v48
    v_bfe_u32 v49, v1, 2, 2
    v_mul_u32_u24 v49, 1040, v49
    v_lshl_add_u32 v49, v3, 5, v49
    v_and_b32 v50, 3, v1
    v_lshl_add_u32 v49, v50, 3, v49
    s_lshl_b32 s50, s22, 8
    s_add_u32 s50, s50, 59392
    v_add_u32 v49, s50, v49
    s_lshl_b32 s50, s2, 13
    s_lshl_b32 s51, s22, 11
    s_add_u32 s50, s50, s51
    s_add_u32 s50, s50, 2097152
    v_add_u32 v50, s50, v5
    s_waitcnt lgkmcnt(0)
    s_barrier
    ds_read_b128 v[52:55], v47
    ds_read_b128 v[56:59], v47 offset:128
    ds_read_b64_tr_b16 v[60:61], v49 offset:0
    ds_read_b64_tr_b16 v[62:63], v49 offset:4160
    ds_read_b64_tr_b16 v[64:65], v49 offset:128
    ds_read_b64_tr_b16 v[66:67], v49 offset:4288
    s_waitcnt lgkmcnt(5)
    global_store_dwordx4 v48, v[52:55], s[4:5] sc1
    s_waitcnt lgkmcnt(4)
    global_store_dwordx4 v51, v[56:59], s[4:5] sc1
    s_waitcnt lgkmcnt(2)
    global_store_dwordx4 v50, v[60:63], s[4:5] sc1
    s_waitcnt lgkmcnt(0)
    global_store_dwordx4 v50, v[64:67], s[4:5] offset:1024 sc1
    s_waitcnt vmcnt(0)
    s_barrier
    s_cmp_lg_u32 s22, 0
    s_cbranch_scc1 L_sig_ln
    s_mov_b32 s55, 0
L_poll_flag_loop:
    global_load_dword v252, v250, s[20:21] sc1
    s_waitcnt vmcnt(0)
    v_readfirstlane_b32 s54, v252
    s_nop 0
    s_cmp_ge_u32 s54, 1
    s_cbranch_scc1 L_poll_flag_ok
    s_add_u32 s55, s55, 1
    s_cmp_ge_u32 s55, 0x40000
    s_cbranch_scc1 L_poll_flag_ok
    s_sleep 2
    s_branch L_poll_flag_loop
L_poll_flag_ok:
    s_lshr_b32 s50, s2, 4
    s_lshl_b32 s50, s50, 8
    s_add_u32 s50, s18, s50
    s_addc_u32 s51, s19, 0
    s_mov_b64 exec, 1
    global_atomic_add v250, v251, s[50:51]
    s_mov_b64 exec, -1
L_sig_ln:
    s_add_u32 s50, s43, 59392
    s_mov_b32 m0, s50
    s_nop 0
    buffer_load_dwordx4 v200, s[8:11], s38 offen lds
    s_add_u32 s50, s43, 60416
    s_mov_b32 m0, s50
    s_nop 0
    buffer_load_dwordx4 v201, s[8:11], s38 offen lds
    s_add_u32 s50, s43, 61440
    s_mov_b32 m0, s50
    s_nop 0
    buffer_load_dwordx4 v202, s[8:11], s38 offen lds
    s_add_u32 s50, s43, 62464
    s_mov_b32 m0, s50
    s_mov_b64 exec, 0xffffffff
    buffer_load_dwordx4 v203, s[8:11], s38 offen lds
    s_mov_b64 exec, -1
    s_lshl_b32 s50, s28, 14
    v_add_u32 v207, s50, v5
    v_mul_u32_u24 v8, 3712, v3
    v_bfe_u32 v9, v1, 2, 2
    v_mul_u32_u24 v9, 224, v9
    v_add_u32 v8, v8, v9
    v_and_b32 v9, 3, v1
    v_lshl_add_u32 v208, v9, 3, v8
    s_mul_i32 s50, s28, 57344
    s_mul_i32 s51, s27, 3584
    s_add_u32 s50, s50, s51
    s_add_u32 s50, s50, 8388608
    v_lshrrev_b32 v10, 1, v3
    v_lshlrev_b32 v10, 8, v10
    v_lshl_add_u32 v10, v4, 4, v10
    v_add_u32 v10, s50, v10
    v_and_b32 v12, 1, v3
    v_lshl_add_u32 v210, v12, 3, v10
    v_lshl_add_u32 v209, v12, 9, v10
    s_and_b32 s29, s2, 3
    s_lshl_b32 s29, s29, 3
    s_bfe_u32 s30, s2, 0x30003
    s_add_u32 s29, s29, s30
    s_bfe_u32 s30, s2, 0x10002
    s_lshl_b32 s30, s30, 2
    s_lshr_b32 s31, s2, 6
    s_add_u32 s30, s30, s31
    s_lshl_b32 s50, s29, 2
    s_add_u32 s50, s50, s22
    s_mul_i32 s51, s50, 57344
    s_add_u32 s51, s51, 8388608
    v_add_u32 v211, s51, v5
    v_lshrrev_b32 v13, 3, v1
    s_lshl_b32 s51, s22, 5
    v_add_u32 v13, s51, v13
    v_lshlrev_b32 v13, 10, v13
    v_bfe_u32 v14, v1, 1, 2
    v_bfe_u32 v15, v1, 4, 1
    v_xor_b32 v14, v14, v15
    v_and_b32 v15, 1, v1
    v_lshl_add_u32 v14, v14, 1, v15
    v_xor_b32 v15, 4, v14
    s_lshl_b32 s54, s30, 7
    v_add_u32 v13, s54, v13
    v_lshl_add_u32 v212, v14, 4, v13
    v_lshl_add_u32 v213, v15, 4, v13
    s_lshl_b32 s45, s22, 12
    v_bfe_u32 v13, v1, 2, 2
    v_lshl_add_u32 v14, v3, 3, v13
    v_lshlrev_b32 v14, 7, v14
    v_and_b32 v15, 3, v1
    v_lshl_add_u32 v14, v15, 3, v14
    v_lshrrev_b32 v15, 1, v13
    v_and_b32 v13, 1, v3
    v_lshl_add_u32 v15, v13, 1, v15
    v_xor_b32 v13, 0, v15
    v_lshl_add_u32 v214, v13, 5, v14
    v_xor_b32 v13, 1, v15
    v_lshl_add_u32 v215, v13, 5, v14
    v_xor_b32 v13, 2, v15
    v_lshl_add_u32 v216, v13, 5, v14
    v_xor_b32 v13, 3, v15
    v_lshl_add_u32 v217, v13, 5, v14
    s_lshl_b32 s51, s50, 4
    v_add_u32 v13, s51, v4
    v_lshlrev_b32 v13, 10, v13
    v_lshl_add_u32 v13, v3, 3, v13
    v_add_u32 v218, s54, v13
    v_lshrrev_b32 v13, 3, v1
    s_lshl_b32 s51, s30, 6
    s_lshl_b32 s55, s22, 4
    s_add_u32 s51, s51, s55
    v_add_u32 v13, s51, v13
    v_lshlrev_b32 v13, 12, v13
    v_and_b32 v14, 7, v1
    v_lshl_add_u32 v13, v14, 4, v13
    s_lshl_b32 s51, s29, 7
    s_add_u32 s51, s51, 16777216
    v_add_u32 v219, s51, v13
    s_bfe_u32 s46, s2, 0x30003
    s_lshl_b32 s46, s46, 1
    s_lshr_b32 s51, s2, 6
    s_mul_i32 s51, s51, 3
    s_add_u32 s46, s46, s51
    s_cmp_ge_u32 s46, 14
    s_cselect_b32 s51, 14, 0
    s_sub_u32 s46, s46, s51
    global_load_dwordx2 v[220:221], v253, s[58:59] offset:0
    global_load_dwordx2 v[222:223], v253, s[58:59] offset:32
    global_load_dwordx2 v[224:225], v253, s[58:59] offset:64
    global_load_dwordx2 v[226:227], v253, s[58:59] offset:96
    global_load_dwordx2 v[228:229], v253, s[58:59] offset:128
    global_load_dwordx2 v[230:231], v253, s[58:59] offset:160
    global_load_dwordx2 v[232:233], v253, s[58:59] offset:192
    s_lshr_b32 s50, s2, 3
    s_bfe_u32 s51, s2, 0x10002
    s_mul_i32 s47, s50, 57344
    s_mul_i32 s48, s51, 1792
    s_add_u32 s47, s47, s48
    s_mul_i32 s49, s50, 57344
    s_lshl_b32 s48, s51, 9
    s_add_u32 s49, s49, s48
    v_add_u32 v7, 0, v0
    v_mul_u32_u24 v8, 9363, v7
    v_lshrrev_b32 v8, 20, v8
    v_mul_u32_u24 v9, 112, v8
    v_sub_u32 v9, v7, v9
    v_mul_u32_u24 v8, 3584, v8
    v_lshl_add_u32 v8, v9, 4, v8
    v_add_u32 v8, s47, v8
    global_load_dwordx4 v[244:247], v8, s[56:57]
    v_lshrrev_b32 v8, 5, v7
    v_and_b32 v9, 31, v7
    v_lshlrev_b32 v8, 10, v8
    v_lshl_add_u32 v8, v9, 4, v8
    v_add_u32 v8, s49, v8
    global_load_dwordx4 v[244:247], v8, s[60:61]
    v_add_u32 v7, 256, v0
    v_mul_u32_u24 v8, 9363, v7
    v_lshrrev_b32 v8, 20, v8
    v_mul_u32_u24 v9, 112, v8
    v_sub_u32 v9, v7, v9
    v_mul_u32_u24 v8, 3584, v8
    v_lshl_add_u32 v8, v9, 4, v8
    v_add_u32 v8, s47, v8
    global_load_dwordx4 v[244:247], v8, s[56:57]
    v_lshrrev_b32 v8, 5, v7
    v_and_b32 v9, 31, v7
    v_lshlrev_b32 v8, 10, v8
    v_lshl_add_u32 v8, v9, 4, v8
    v_add_u32 v8, s49, v8
    global_load_dwordx4 v[244:247], v8, s[60:61]
    v_add_u32 v7, 512, v0
    v_mul_u32_u24 v8, 9363, v7
    v_lshrrev_b32 v8, 20, v8
    v_mul_u32_u24 v9, 112, v8
    v_sub_u32 v9, v7, v9
    v_mul_u32_u24 v8, 3584, v8
    v_lshl_add_u32 v8, v9, 4, v8
    v_add_u32 v8, s47, v8
    global_load_dwordx4 v[244:247], v8, s[56:57]
    v_lshrrev_b32 v8, 5, v7
    v_and_b32 v9, 31, v7
    v_lshlrev_b32 v8, 10, v8
    v_lshl_add_u32 v8, v9, 4, v8
    v_add_u32 v8, s49, v8
    global_load_dwordx4 v[244:247], v8, s[60:61]
    v_add_u32 v7, 768, v0
    v_mul_u32_u24 v8, 9363, v7
    v_lshrrev_b32 v8, 20, v8
    v_mul_u32_u24 v9, 112, v8
    v_sub_u32 v9, v7, v9
    v_mul_u32_u24 v8, 3584, v8
    v_lshl_add_u32 v8, v9, 4, v8
    v_add_u32 v8, s47, v8
    global_load_dwordx4 v[244:247], v8, s[56:57]
    v_lshrrev_b32 v8, 5, v7
    v_and_b32 v9, 31, v7
    v_lshlrev_b32 v8, 10, v8
    v_lshl_add_u32 v8, v9, 4, v8
    v_add_u32 v8, s49, v8
    global_load_dwordx4 v[244:247], v8, s[60:61]
    v_add_u32 v7, 1024, v0
    v_mul_u32_u24 v8, 9363, v7
    v_lshrrev_b32 v8, 20, v8
    v_mul_u32_u24 v9, 112, v8
    v_sub_u32 v9, v7, v9
    v_mul_u32_u24 v8, 3584, v8
    v_lshl_add_u32 v8, v9, 4, v8
    v_add_u32 v8, s47, v8
    global_load_dwordx4 v[244:247], v8, s[56:57]
    v_lshrrev_b32 v8, 5, v7
    v_and_b32 v9, 31, v7
    v_lshlrev_b32 v8, 10, v8
    v_lshl_add_u32 v8, v9, 4, v8
    v_add_u32 v8, s49, v8
    global_load_dwordx4 v[244:247], v8, s[60:61]
    v_add_u32 v7, 1280, v0
    v_mul_u32_u24 v8, 9363, v7
    v_lshrrev_b32 v8, 20, v8
    v_mul_u32_u24 v9, 112, v8
    v_sub_u32 v9, v7, v9
    v_mul_u32_u24 v8, 3584, v8
    v_lshl_add_u32 v8, v9, 4, v8
    v_add_u32 v8, s47, v8
    global_load_dwordx4 v[244:247], v8, s[56:57]
    v_lshrrev_b32 v8, 5, v7
    v_and_b32 v9, 31, v7
    v_lshlrev_b32 v8, 10, v8
    v_lshl_add_u32 v8, v9, 4, v8
    v_add_u32 v8, s49, v8
    global_load_dwordx4 v[244:247], v8, s[60:61]
    v_add_u32 v7, 1536, v0
    v_mul_u32_u24 v8, 9363, v7
    v_lshrrev_b32 v8, 20, v8
    v_mul_u32_u24 v9, 112, v8
    v_sub_u32 v9, v7, v9
    v_mul_u32_u24 v8, 3584, v8
    v_lshl_add_u32 v8, v9, 4, v8
    v_add_u32 v8, s47, v8
    global_load_dwordx4 v[244:247], v8, s[56:57]
    v_lshrrev_b32 v8, 5, v7
    v_and_b32 v9, 31, v7
    v_lshlrev_b32 v8, 10, v8
    v_lshl_add_u32 v8, v9, 4, v8
    v_add_u32 v8, s49, v8
    global_load_dwordx4 v[244:247], v8, s[60:61]
    s_cmp_lg_u32 s22, 0
    s_cbranch_scc1 L_poll_ln_skip
    s_mov_b32 s50, s26
    s_lshl_b32 s50, s50, 8
    s_add_u32 s50, s18, s50
    s_addc_u32 s51, s19, 0
    s_mov_b32 s55, 0
L_poll_ln_loop:
    global_load_dword v252, v250, s[50:51] sc1
    s_waitcnt vmcnt(0)
    v_readfirstlane_b32 s54, v252
    s_nop 0
    s_cmp_ge_u32 s54, 16
    s_cbranch_scc1 L_poll_ln_ok
    s_add_u32 s55, s55, 1
    s_cmp_ge_u32 s55, 0x40000
    s_cbranch_scc1 L_poll_ln_ok
    s_sleep 2
    s_branch L_poll_ln_loop
L_poll_ln_ok:
L_poll_ln_skip:
    s_waitcnt vmcnt(21)
    s_waitcnt vmcnt(14)
    s_barrier
    v_add_u32 v253, s68, v207
    v_add_u32 v252, 0x4000, v253
    global_load_dwordx4 v[16:19], v253, s[4:5] offset:0 sc1
    global_load_dwordx4 v[20:23], v252, s[4:5] offset:0 sc1
    global_load_dwordx4 v[24:27], v253, s[4:5] offset:1024 sc1
    global_load_dwordx4 v[28:31], v252, s[4:5] offset:1024 sc1
    v_add_u32 v253, s69, v207
    v_add_u32 v252, 0x4000, v253
    global_load_dwordx4 v[32:35], v253, s[4:5] offset:0 sc1
    global_load_dwordx4 v[36:39], v252, s[4:5] offset:0 sc1
    global_load_dwordx4 v[40:43], v253, s[4:5] offset:1024 sc1
    global_load_dwordx4 v[44:47], v252, s[4:5] offset:1024 sc1
    v_add_u32 v253, s70, v207
    v_add_u32 v252, 0x4000, v253
    global_load_dwordx4 v[48:51], v253, s[4:5] offset:0 sc1
    global_load_dwordx4 v[52:55], v252, s[4:5] offset:0 sc1
    global_load_dwordx4 v[56:59], v253, s[4:5] offset:1024 sc1
    global_load_dwordx4 v[60:63], v252, s[4:5] offset:1024 sc1
    v_add_u32 v253, s71, v207
    v_add_u32 v252, 0x4000, v253
    global_load_dwordx4 v[64:67], v253, s[4:5] offset:0 sc1
    global_load_dwordx4 v[68:71], v252, s[4:5] offset:0 sc1
    global_load_dwordx4 v[72:75], v253, s[4:5] offset:1024 sc1
    global_load_dwordx4 v[76:79], v252, s[4:5] offset:1024 sc1
    v_lshlrev_b32 v136, 16, v220
    v_and_b32 v137, 0xffff0000, v220
    v_lshlrev_b32 v138, 16, v221
    v_and_b32 v139, 0xffff0000, v221
    v_lshlrev_b32 v140, 16, v222
    v_and_b32 v141, 0xffff0000, v222
    v_lshlrev_b32 v142, 16, v223
    v_and_b32 v143, 0xffff0000, v223
    v_lshlrev_b32 v144, 16, v224
    v_and_b32 v145, 0xffff0000, v224
    v_lshlrev_b32 v146, 16, v225
    v_and_b32 v147, 0xffff0000, v225
    v_lshlrev_b32 v148, 16, v226
    v_and_b32 v149, 0xffff0000, v226
    v_lshlrev_b32 v150, 16, v227
    v_and_b32 v151, 0xffff0000, v227
    v_lshlrev_b32 v152, 16, v228
    v_and_b32 v153, 0xffff0000, v228
    v_lshlrev_b32 v154, 16, v229
    v_and_b32 v155, 0xffff0000, v229
    v_lshlrev_b32 v156, 16, v230
    v_and_b32 v157, 0xffff0000, v230
    v_lshlrev_b32 v158, 16, v231
    v_and_b32 v159, 0xffff0000, v231
    v_lshlrev_b32 v160, 16, v232
    v_and_b32 v161, 0xffff0000, v232
    v_lshlrev_b32 v162, 16, v233
    v_and_b32 v163, 0xffff0000, v233
    v_lshlrev_b32 v164, 16, v220
    v_and_b32 v165, 0xffff0000, v220
    v_lshlrev_b32 v166, 16, v221
    v_and_b32 v167, 0xffff0000, v221
    v_lshlrev_b32 v168, 16, v222
    v_and_b32 v169, 0xffff0000, v222
    v_lshlrev_b32 v170, 16, v223
    v_and_b32 v171, 0xffff0000, v223
    v_lshlrev_b32 v172, 16, v224
    v_and_b32 v173, 0xffff0000, v224
    v_lshlrev_b32 v174, 16, v225
    v_and_b32 v175, 0xffff0000, v225
    v_lshlrev_b32 v176, 16, v226
    v_and_b32 v177, 0xffff0000, v226
    v_lshlrev_b32 v178, 16, v227
    v_and_b32 v179, 0xffff0000, v227
    v_lshlrev_b32 v180, 16, v228
    v_and_b32 v181, 0xffff0000, v228
    v_lshlrev_b32 v182, 16, v229
    v_and_b32 v183, 0xffff0000, v229
    v_lshlrev_b32 v184, 16, v230
    v_and_b32 v185, 0xffff0000, v230
    v_lshlrev_b32 v186, 16, v231
    v_and_b32 v187, 0xffff0000, v231
    v_lshlrev_b32 v188, 16, v232
    v_and_b32 v189, 0xffff0000, v232
    v_lshlrev_b32 v190, 16, v233
    v_and_b32 v191, 0xffff0000, v233
    ds_read_b64_tr_b16 v[80:81], v208 offset:0
    ds_read_b64_tr_b16 v[82:83], v208 offset:896
    ds_read_b64_tr_b16 v[84:85], v208 offset:32
    ds_read_b64_tr_b16 v[86:87], v208 offset:928
    ds_read_b64_tr_b16 v[88:89], v208 offset:64
    ds_read_b64_tr_b16 v[90:91], v208 offset:960
    ds_read_b64_tr_b16 v[92:93], v208 offset:96
    ds_read_b64_tr_b16 v[94:95], v208 offset:992
    ds_read_b64_tr_b16 v[96:97], v208 offset:128
    ds_read_b64_tr_b16 v[98:99], v208 offset:1024
    ds_read_b64_tr_b16 v[100:101], v208 offset:160
    ds_read_b64_tr_b16 v[102:103], v208 offset:1056
    ds_read_b64_tr_b16 v[104:105], v208 offset:192
    ds_read_b64_tr_b16 v[106:107], v208 offset:1088
    s_waitcnt vmcnt(14)
    ds_read_b64_tr_b16 v[108:109], v208 offset:1792
    ds_read_b64_tr_b16 v[110:111], v208 offset:2688
    s_waitcnt lgkmcnt(14)
    v_mfma_f32_16x16x32_bf16 v[136:139], v[80:83], v[16:19], v[136:139]
    v_mfma_f32_16x16x32_bf16 v[164:167], v[80:83], v[20:23], v[164:167]
    ds_read_b64_tr_b16 v[112:113], v208 offset:1824
    ds_read_b64_tr_b16 v[114:115], v208 offset:2720
    s_waitcnt lgkmcnt(14)
    v_mfma_f32_16x16x32_bf16 v[140:143], v[84:87], v[16:19], v[140:143]
    v_mfma_f32_16x16x32_bf16 v[168:171], v[84:87], v[20:23], v[168:171]
    ds_read_b64_tr_b16 v[116:117], v208 offset:1856
    ds_read_b64_tr_b16 v[118:119], v208 offset:2752
    s_waitcnt lgkmcnt(14)
    v_mfma_f32_16x16x32_bf16 v[144:147], v[88:91], v[16:19], v[144:147]
    v_mfma_f32_16x16x32_bf16 v[172:175], v[88:91], v[20:23], v[172:175]
    ds_read_b64_tr_b16 v[120:121], v208 offset:1888
    ds_read_b64_tr_b16 v[122:123], v208 offset:2784
    s_waitcnt lgkmcnt(14)
    v_mfma_f32_16x16x32_bf16 v[148:151], v[92:95], v[16:19], v[148:151]
    v_mfma_f32_16x16x32_bf16 v[176:179], v[92:95], v[20:23], v[176:179]
    ds_read_b64_tr_b16 v[124:125], v208 offset:1920
    ds_read_b64_tr_b16 v[126:127], v208 offset:2816
    s_waitcnt lgkmcnt(14)
    v_mfma_f32_16x16x32_bf16 v[152:155], v[96:99], v[16:19], v[152:155]
    v_mfma_f32_16x16x32_bf16 v[180:183], v[96:99], v[20:23], v[180:183]
    ds_read_b64_tr_b16 v[128:129], v208 offset:1952
    ds_read_b64_tr_b16 v[130:131], v208 offset:2848
    s_waitcnt lgkmcnt(14)
    v_mfma_f32_16x16x32_bf16 v[156:159], v[100:103], v[16:19], v[156:159]
    v_mfma_f32_16x16x32_bf16 v[184:187], v[100:103], v[20:23], v[184:187]
    ds_read_b64_tr_b16 v[132:133], v208 offset:1984
    ds_read_b64_tr_b16 v[134:135], v208 offset:2880
    s_waitcnt lgkmcnt(14)
    v_mfma_f32_16x16x32_bf16 v[160:163], v[104:107], v[16:19], v[160:163]
    v_mfma_f32_16x16x32_bf16 v[188:191], v[104:107], v[20:23], v[188:191]
    s_waitcnt lgkmcnt(0)
    s_barrier
    s_add_u32 s50, s43, 0
    s_mov_b32 m0, s50
    s_nop 0
    buffer_load_dwordx4 v200, s[8:11], s39 offen lds
    s_add_u32 s50, s43, 1024
    s_mov_b32 m0, s50
    s_nop 0
    buffer_load_dwordx4 v201, s[8:11], s39 offen lds
    s_add_u32 s50, s43, 2048
    s_mov_b32 m0, s50
    s_nop 0
    buffer_load_dwordx4 v202, s[8:11], s39 offen lds
    s_add_u32 s50, s43, 3072
    s_mov_b32 m0, s50
    s_mov_b64 exec, 0xffffffff
    buffer_load_dwordx4 v203, s[8:11], s39 offen lds
    s_mov_b64 exec, -1
    s_waitcnt vmcnt(16)
    ds_read_b64_tr_b16 v[80:81], v208 offset:14848
    ds_read_b64_tr_b16 v[82:83], v208 offset:15744
    v_mfma_f32_16x16x32_bf16 v[136:139], v[108:111], v[24:27], v[136:139]
    v_mfma_f32_16x16x32_bf16 v[164:167], v[108:111], v[28:31], v[164:167]
    ds_read_b64_tr_b16 v[84:85], v208 offset:14880
    ds_read_b64_tr_b16 v[86:87], v208 offset:15776
    v_mfma_f32_16x16x32_bf16 v[140:143], v[112:115], v[24:27], v[140:143]
    v_mfma_f32_16x16x32_bf16 v[168:171], v[112:115], v[28:31], v[168:171]
    ds_read_b64_tr_b16 v[88:89], v208 offset:14912
    ds_read_b64_tr_b16 v[90:91], v208 offset:15808
    v_mfma_f32_16x16x32_bf16 v[144:147], v[116:119], v[24:27], v[144:147]
    v_mfma_f32_16x16x32_bf16 v[172:175], v[116:119], v[28:31], v[172:175]
    ds_read_b64_tr_b16 v[92:93], v208 offset:14944
    ds_read_b64_tr_b16 v[94:95], v208 offset:15840
    v_mfma_f32_16x16x32_bf16 v[148:151], v[120:123], v[24:27], v[148:151]
    v_mfma_f32_16x16x32_bf16 v[176:179], v[120:123], v[28:31], v[176:179]
    ds_read_b64_tr_b16 v[96:97], v208 offset:14976
    ds_read_b64_tr_b16 v[98:99], v208 offset:15872
    v_mfma_f32_16x16x32_bf16 v[152:155], v[124:127], v[24:27], v[152:155]
    v_mfma_f32_16x16x32_bf16 v[180:183], v[124:127], v[28:31], v[180:183]
    ds_read_b64_tr_b16 v[100:101], v208 offset:15008
    ds_read_b64_tr_b16 v[102:103], v208 offset:15904
    v_mfma_f32_16x16x32_bf16 v[156:159], v[128:131], v[24:27], v[156:159]
    v_mfma_f32_16x16x32_bf16 v[184:187], v[128:131], v[28:31], v[184:187]
    ds_read_b64_tr_b16 v[104:105], v208 offset:15040
    ds_read_b64_tr_b16 v[106:107], v208 offset:15936
    v_mfma_f32_16x16x32_bf16 v[160:163], v[132:135], v[24:27], v[160:163]
    v_mfma_f32_16x16x32_bf16 v[188:191], v[132:135], v[28:31], v[188:191]
    v_add_u32 v253, s72, v207
    v_add_u32 v252, 0x4000, v253
    global_load_dwordx4 v[16:19], v253, s[4:5] offset:0 sc1
    global_load_dwordx4 v[20:23], v252, s[4:5] offset:0 sc1
    global_load_dwordx4 v[24:27], v253, s[4:5] offset:1024 sc1
    global_load_dwordx4 v[28:31], v252, s[4:5] offset:1024 sc1
    s_waitcnt vmcnt(18)
    ds_read_b64_tr_b16 v[108:109], v208 offset:16640
    ds_read_b64_tr_b16 v[110:111], v208 offset:17536
    s_waitcnt lgkmcnt(14)
    v_mfma_f32_16x16x32_bf16 v[136:139], v[80:83], v[32:35], v[136:139]
    v_mfma_f32_16x16x32_bf16 v[164:167], v[80:83], v[36:39], v[164:167]
    ds_read_b64_tr_b16 v[112:113], v208 offset:16672
    ds_read_b64_tr_b16 v[114:115], v208 offset:17568
    s_waitcnt lgkmcnt(14)
    v_mfma_f32_16x16x32_bf16 v[140:143], v[84:87], v[32:35], v[140:143]
    v_mfma_f32_16x16x32_bf16 v[168:171], v[84:87], v[36:39], v[168:171]
    ds_read_b64_tr_b16 v[116:117], v208 offset:16704
    ds_read_b64_tr_b16 v[118:119], v208 offset:17600
    s_waitcnt lgkmcnt(14)
    v_mfma_f32_16x16x32_bf16 v[144:147], v[88:91], v[32:35], v[144:147]
    v_mfma_f32_16x16x32_bf16 v[172:175], v[88:91], v[36:39], v[172:175]
    ds_read_b64_tr_b16 v[120:121], v208 offset:16736
    ds_read_b64_tr_b16 v[122:123], v208 offset:17632
    s_waitcnt lgkmcnt(14)
    v_mfma_f32_16x16x32_bf16 v[148:151], v[92:95], v[32:35], v[148:151]
    v_mfma_f32_16x16x32_bf16 v[176:179], v[92:95], v[36:39], v[176:179]
    ds_read_b64_tr_b16 v[124:125], v208 offset:16768
    ds_read_b64_tr_b16 v[126:127], v208 offset:17664
    s_waitcnt lgkmcnt(14)
    v_mfma_f32_16x16x32_bf16 v[152:155], v[96:99], v[32:35], v[152:155]
    v_mfma_f32_16x16x32_bf16 v[180:183], v[96:99], v[36:39], v[180:183]
    ds_read_b64_tr_b16 v[128:129], v208 offset:16800
    ds_read_b64_tr_b16 v[130:131], v208 offset:17696
    s_waitcnt lgkmcnt(14)
    v_mfma_f32_16x16x32_bf16 v[156:159], v[100:103], v[32:35], v[156:159]
    v_mfma_f32_16x16x32_bf16 v[184:187], v[100:103], v[36:39], v[184:187]
    ds_read_b64_tr_b16 v[132:133], v208 offset:16832
    ds_read_b64_tr_b16 v[134:135], v208 offset:17728
    s_waitcnt lgkmcnt(14)
    v_mfma_f32_16x16x32_bf16 v[160:163], v[104:107], v[32:35], v[160:163]
    v_mfma_f32_16x16x32_bf16 v[188:191], v[104:107], v[36:39], v[188:191]
    s_waitcnt lgkmcnt(0)
    s_barrier
    s_add_u32 s50, s43, 14848
    s_mov_b32 m0, s50
    s_nop 0
    buffer_load_dwordx4 v200, s[8:11], s40 offen lds
    s_add_u32 s50, s43, 15872
    s_mov_b32 m0, s50
    s_nop 0
    buffer_load_dwordx4 v201, s[8:11], s40 offen lds
    s_add_u32 s50, s43, 16896
    s_mov_b32 m0, s50
    s_nop 0
    buffer_load_dwordx4 v202, s[8:11], s40 offen lds
    s_add_u32 s50, s43, 17920
    s_mov_b32 m0, s50
    s_mov_b64 exec, 0xffffffff
    buffer_load_dwordx4 v203, s[8:11], s40 offen lds
    s_mov_b64 exec, -1
    s_waitcnt vmcnt(20)
    ds_read_b64_tr_b16 v[80:81], v208 offset:29696
    ds_read_b64_tr_b16 v[82:83], v208 offset:30592
    v_mfma_f32_16x16x32_bf16 v[136:139], v[108:111], v[40:43], v[136:139]
    v_mfma_f32_16x16x32_bf16 v[164:167], v[108:111], v[44:47], v[164:167]
    ds_read_b64_tr_b16 v[84:85], v208 offset:29728
    ds_read_b64_tr_b16 v[86:87], v208 offset:30624
    v_mfma_f32_16x16x32_bf16 v[140:143], v[112:115], v[40:43], v[140:143]
    v_mfma_f32_16x16x32_bf16 v[168:171], v[112:115], v[44:47], v[168:171]
    ds_read_b64_tr_b16 v[88:89], v208 offset:29760
    ds_read_b64_tr_b16 v[90:91], v208 offset:30656
    v_mfma_f32_16x16x32_bf16 v[144:147], v[116:119], v[40:43], v[144:147]
    v_mfma_f32_16x16x32_bf16 v[172:175], v[116:119], v[44:47], v[172:175]
    ds_read_b64_tr_b16 v[92:93], v208 offset:29792
    ds_read_b64_tr_b16 v[94:95], v208 offset:30688
    v_mfma_f32_16x16x32_bf16 v[148:151], v[120:123], v[40:43], v[148:151]
    v_mfma_f32_16x16x32_bf16 v[176:179], v[120:123], v[44:47], v[176:179]
    ds_read_b64_tr_b16 v[96:97], v208 offset:29824
    ds_read_b64_tr_b16 v[98:99], v208 offset:30720
    v_mfma_f32_16x16x32_bf16 v[152:155], v[124:127], v[40:43], v[152:155]
    v_mfma_f32_16x16x32_bf16 v[180:183], v[124:127], v[44:47], v[180:183]
    ds_read_b64_tr_b16 v[100:101], v208 offset:29856
    ds_read_b64_tr_b16 v[102:103], v208 offset:30752
    v_mfma_f32_16x16x32_bf16 v[156:159], v[128:131], v[40:43], v[156:159]
    v_mfma_f32_16x16x32_bf16 v[184:187], v[128:131], v[44:47], v[184:187]
    ds_read_b64_tr_b16 v[104:105], v208 offset:29888
    ds_read_b64_tr_b16 v[106:107], v208 offset:30784
    v_mfma_f32_16x16x32_bf16 v[160:163], v[132:135], v[40:43], v[160:163]
    v_mfma_f32_16x16x32_bf16 v[188:191], v[132:135], v[44:47], v[188:191]
    v_add_u32 v253, s73, v207
    v_add_u32 v252, 0x4000, v253
    global_load_dwordx4 v[32:35], v253, s[4:5] offset:0 sc1
    global_load_dwordx4 v[36:39], v252, s[4:5] offset:0 sc1
    global_load_dwordx4 v[40:43], v253, s[4:5] offset:1024 sc1
    global_load_dwordx4 v[44:47], v252, s[4:5] offset:1024 sc1
    s_waitcnt vmcnt(22)
    ds_read_b64_tr_b16 v[108:109], v208 offset:31488
    ds_read_b64_tr_b16 v[110:111], v208 offset:32384
    s_waitcnt lgkmcnt(14)
    v_mfma_f32_16x16x32_bf16 v[136:139], v[80:83], v[48:51], v[136:139]
    v_mfma_f32_16x16x32_bf16 v[164:167], v[80:83], v[52:55], v[164:167]
    ds_read_b64_tr_b16 v[112:113], v208 offset:31520
    ds_read_b64_tr_b16 v[114:115], v208 offset:32416
    s_waitcnt lgkmcnt(14)
    v_mfma_f32_16x16x32_bf16 v[140:143], v[84:87], v[48:51], v[140:143]
    v_mfma_f32_16x16x32_bf16 v[168:171], v[84:87], v[52:55], v[168:171]
    ds_read_b64_tr_b16 v[116:117], v208 offset:31552
    ds_read_b64_tr_b16 v[118:119], v208 offset:32448
    s_waitcnt lgkmcnt(14)
    v_mfma_f32_16x16x32_bf16 v[144:147], v[88:91], v[48:51], v[144:147]
    v_mfma_f32_16x16x32_bf16 v[172:175], v[88:91], v[52:55], v[172:175]
    ds_read_b64_tr_b16 v[120:121], v208 offset:31584
    ds_read_b64_tr_b16 v[122:123], v208 offset:32480
    s_waitcnt lgkmcnt(14)
    v_mfma_f32_16x16x32_bf16 v[148:151], v[92:95], v[48:51], v[148:151]
    v_mfma_f32_16x16x32_bf16 v[176:179], v[92:95], v[52:55], v[176:179]
    ds_read_b64_tr_b16 v[124:125], v208 offset:31616
    ds_read_b64_tr_b16 v[126:127], v208 offset:32512
    s_waitcnt lgkmcnt(14)
    v_mfma_f32_16x16x32_bf16 v[152:155], v[96:99], v[48:51], v[152:155]
    v_mfma_f32_16x16x32_bf16 v[180:183], v[96:99], v[52:55], v[180:183]
    ds_read_b64_tr_b16 v[128:129], v208 offset:31648
    ds_read_b64_tr_b16 v[130:131], v208 offset:32544
    s_waitcnt lgkmcnt(14)
    v_mfma_f32_16x16x32_bf16 v[156:159], v[100:103], v[48:51], v[156:159]
    v_mfma_f32_16x16x32_bf16 v[184:187], v[100:103], v[52:55], v[184:187]
    ds_read_b64_tr_b16 v[132:133], v208 offset:31680
    ds_read_b64_tr_b16 v[134:135], v208 offset:32576
    s_waitcnt lgkmcnt(14)
    v_mfma_f32_16x16x32_bf16 v[160:163], v[104:107], v[48:51], v[160:163]
    v_mfma_f32_16x16x32_bf16 v[188:191], v[104:107], v[52:55], v[188:191]
    s_waitcnt lgkmcnt(0)
    s_barrier
    s_add_u32 s50, s43, 29696
    s_mov_b32 m0, s50
    s_nop 0
    buffer_load_dwordx4 v200, s[8:11], s41 offen lds
    s_add_u32 s50, s43, 30720
    s_mov_b32 m0, s50
    s_nop 0
    buffer_load_dwordx4 v201, s[8:11], s41 offen lds
    s_add_u32 s50, s43, 31744
    s_mov_b32 m0, s50
    s_nop 0
    buffer_load_dwordx4 v202, s[8:11], s41 offen lds
    s_add_u32 s50, s43, 32768
    s_mov_b32 m0, s50
    s_mov_b64 exec, 0xffffffff
    buffer_load_dwordx4 v203, s[8:11], s41 offen lds
    s_mov_b64 exec, -1
    s_waitcnt vmcnt(24)
    ds_read_b64_tr_b16 v[80:81], v208 offset:44544
    ds_read_b64_tr_b16 v[82:83], v208 offset:45440
    v_mfma_f32_16x16x32_bf16 v[136:139], v[108:111], v[56:59], v[136:139]
    v_mfma_f32_16x16x32_bf16 v[164:167], v[108:111], v[60:63], v[164:167]
    ds_read_b64_tr_b16 v[84:85], v208 offset:44576
    ds_read_b64_tr_b16 v[86:87], v208 offset:45472
    v_mfma_f32_16x16x32_bf16 v[140:143], v[112:115], v[56:59], v[140:143]
    v_mfma_f32_16x16x32_bf16 v[168:171], v[112:115], v[60:63], v[168:171]
    ds_read_b64_tr_b16 v[88:89], v208 offset:44608
    ds_read_b64_tr_b16 v[90:91], v208 offset:45504
    v_mfma_f32_16x16x32_bf16 v[144:147], v[116:119], v[56:59], v[144:147]
    v_mfma_f32_16x16x32_bf16 v[172:175], v[116:119], v[60:63], v[172:175]
    ds_read_b64_tr_b16 v[92:93], v208 offset:44640
    ds_read_b64_tr_b16 v[94:95], v208 offset:45536
    v_mfma_f32_16x16x32_bf16 v[148:151], v[120:123], v[56:59], v[148:151]
    v_mfma_f32_16x16x32_bf16 v[176:179], v[120:123], v[60:63], v[176:179]
    ds_read_b64_tr_b16 v[96:97], v208 offset:44672
    ds_read_b64_tr_b16 v[98:99], v208 offset:45568
    v_mfma_f32_16x16x32_bf16 v[152:155], v[124:127], v[56:59], v[152:155]
    v_mfma_f32_16x16x32_bf16 v[180:183], v[124:127], v[60:63], v[180:183]
    ds_read_b64_tr_b16 v[100:101], v208 offset:44704
    ds_read_b64_tr_b16 v[102:103], v208 offset:45600
    v_mfma_f32_16x16x32_bf16 v[156:159], v[128:131], v[56:59], v[156:159]
    v_mfma_f32_16x16x32_bf16 v[184:187], v[128:131], v[60:63], v[184:187]
    ds_read_b64_tr_b16 v[104:105], v208 offset:44736
    ds_read_b64_tr_b16 v[106:107], v208 offset:45632
    v_mfma_f32_16x16x32_bf16 v[160:163], v[132:135], v[56:59], v[160:163]
    v_mfma_f32_16x16x32_bf16 v[188:191], v[132:135], v[60:63], v[188:191]
    v_add_u32 v253, s74, v207
    v_add_u32 v252, 0x4000, v253
    global_load_dwordx4 v[48:51], v253, s[4:5] offset:0 sc1
    global_load_dwordx4 v[52:55], v252, s[4:5] offset:0 sc1
    global_load_dwordx4 v[56:59], v253, s[4:5] offset:1024 sc1
    global_load_dwordx4 v[60:63], v252, s[4:5] offset:1024 sc1
    s_waitcnt vmcnt(26)
    ds_read_b64_tr_b16 v[108:109], v208 offset:46336
    ds_read_b64_tr_b16 v[110:111], v208 offset:47232
    s_waitcnt lgkmcnt(14)
    v_mfma_f32_16x16x32_bf16 v[136:139], v[80:83], v[64:67], v[136:139]
    v_mfma_f32_16x16x32_bf16 v[164:167], v[80:83], v[68:71], v[164:167]
    ds_read_b64_tr_b16 v[112:113], v208 offset:46368
    ds_read_b64_tr_b16 v[114:115], v208 offset:47264
    s_waitcnt lgkmcnt(14)
    v_mfma_f32_16x16x32_bf16 v[140:143], v[84:87], v[64:67], v[140:143]
    v_mfma_f32_16x16x32_bf16 v[168:171], v[84:87], v[68:71], v[168:171]
    ds_read_b64_tr_b16 v[116:117], v208 offset:46400
    ds_read_b64_tr_b16 v[118:119], v208 offset:47296
    s_waitcnt lgkmcnt(14)
    v_mfma_f32_16x16x32_bf16 v[144:147], v[88:91], v[64:67], v[144:147]
    v_mfma_f32_16x16x32_bf16 v[172:175], v[88:91], v[68:71], v[172:175]
    ds_read_b64_tr_b16 v[120:121], v208 offset:46432
    ds_read_b64_tr_b16 v[122:123], v208 offset:47328
    s_waitcnt lgkmcnt(14)
    v_mfma_f32_16x16x32_bf16 v[148:151], v[92:95], v[64:67], v[148:151]
    v_mfma_f32_16x16x32_bf16 v[176:179], v[92:95], v[68:71], v[176:179]
    ds_read_b64_tr_b16 v[124:125], v208 offset:46464
    ds_read_b64_tr_b16 v[126:127], v208 offset:47360
    s_waitcnt lgkmcnt(14)
    v_mfma_f32_16x16x32_bf16 v[152:155], v[96:99], v[64:67], v[152:155]
    v_mfma_f32_16x16x32_bf16 v[180:183], v[96:99], v[68:71], v[180:183]
    ds_read_b64_tr_b16 v[128:129], v208 offset:46496
    ds_read_b64_tr_b16 v[130:131], v208 offset:47392
    s_waitcnt lgkmcnt(14)
    v_mfma_f32_16x16x32_bf16 v[156:159], v[100:103], v[64:67], v[156:159]
    v_mfma_f32_16x16x32_bf16 v[184:187], v[100:103], v[68:71], v[184:187]
    ds_read_b64_tr_b16 v[132:133], v208 offset:46528
    ds_read_b64_tr_b16 v[134:135], v208 offset:47424
    s_waitcnt lgkmcnt(14)
    v_mfma_f32_16x16x32_bf16 v[160:163], v[104:107], v[64:67], v[160:163]
    v_mfma_f32_16x16x32_bf16 v[188:191], v[104:107], v[68:71], v[188:191]
    s_waitcnt lgkmcnt(0)
    s_barrier
    s_waitcnt vmcnt(24)
    ds_read_b64_tr_b16 v[80:81], v208 offset:59392
    ds_read_b64_tr_b16 v[82:83], v208 offset:60288
    v_mfma_f32_16x16x32_bf16 v[136:139], v[108:111], v[72:75], v[136:139]
    v_mfma_f32_16x16x32_bf16 v[164:167], v[108:111], v[76:79], v[164:167]
    ds_read_b64_tr_b16 v[84:85], v208 offset:59424
    ds_read_b64_tr_b16 v[86:87], v208 offset:60320
    v_mfma_f32_16x16x32_bf16 v[140:143], v[112:115], v[72:75], v[140:143]
    v_mfma_f32_16x16x32_bf16 v[168:171], v[112:115], v[76:79], v[168:171]
    ds_read_b64_tr_b16 v[88:89], v208 offset:59456
    ds_read_b64_tr_b16 v[90:91], v208 offset:60352
    v_mfma_f32_16x16x32_bf16 v[144:147], v[116:119], v[72:75], v[144:147]
    v_mfma_f32_16x16x32_bf16 v[172:175], v[116:119], v[76:79], v[172:175]
    ds_read_b64_tr_b16 v[92:93], v208 offset:59488
    ds_read_b64_tr_b16 v[94:95], v208 offset:60384
    v_mfma_f32_16x16x32_bf16 v[148:151], v[120:123], v[72:75], v[148:151]
    v_mfma_f32_16x16x32_bf16 v[176:179], v[120:123], v[76:79], v[176:179]
    ds_read_b64_tr_b16 v[96:97], v208 offset:59520
    ds_read_b64_tr_b16 v[98:99], v208 offset:60416
    v_mfma_f32_16x16x32_bf16 v[152:155], v[124:127], v[72:75], v[152:155]
    v_mfma_f32_16x16x32_bf16 v[180:183], v[124:127], v[76:79], v[180:183]
    ds_read_b64_tr_b16 v[100:101], v208 offset:59552
    ds_read_b64_tr_b16 v[102:103], v208 offset:60448
    v_mfma_f32_16x16x32_bf16 v[156:159], v[128:131], v[72:75], v[156:159]
    v_mfma_f32_16x16x32_bf16 v[184:187], v[128:131], v[76:79], v[184:187]
    ds_read_b64_tr_b16 v[104:105], v208 offset:59584
    ds_read_b64_tr_b16 v[106:107], v208 offset:60480
    v_mfma_f32_16x16x32_bf16 v[160:163], v[132:135], v[72:75], v[160:163]
    v_mfma_f32_16x16x32_bf16 v[188:191], v[132:135], v[76:79], v[188:191]
    v_add_u32 v253, s75, v207
    v_add_u32 v252, 0x4000, v253
    global_load_dwordx4 v[64:67], v253, s[4:5] offset:0 sc1
    global_load_dwordx4 v[68:71], v252, s[4:5] offset:0 sc1
    global_load_dwordx4 v[72:75], v253, s[4:5] offset:1024 sc1
    global_load_dwordx4 v[76:79], v252, s[4:5] offset:1024 sc1
    s_waitcnt vmcnt(22)
    ds_read_b64_tr_b16 v[108:109], v208 offset:61184
    ds_read_b64_tr_b16 v[110:111], v208 offset:62080
    s_waitcnt lgkmcnt(14)
    v_mfma_f32_16x16x32_bf16 v[136:139], v[80:83], v[16:19], v[136:139]
    v_mfma_f32_16x16x32_bf16 v[164:167], v[80:83], v[20:23], v[164:167]
    ds_read_b64_tr_b16 v[112:113], v208 offset:61216
    ds_read_b64_tr_b16 v[114:115], v208 offset:62112
    s_waitcnt lgkmcnt(14)
    v_mfma_f32_16x16x32_bf16 v[140:143], v[84:87], v[16:19], v[140:143]
    v_mfma_f32_16x16x32_bf16 v[168:171], v[84:87], v[20:23], v[168:171]
    ds_read_b64_tr_b16 v[116:117], v208 offset:61248
    ds_read_b64_tr_b16 v[118:119], v208 offset:62144
    s_waitcnt lgkmcnt(14)
    v_mfma_f32_16x16x32_bf16 v[144:147], v[88:91], v[16:19], v[144:147]
    v_mfma_f32_16x16x32_bf16 v[172:175], v[88:91], v[20:23], v[172:175]
    ds_read_b64_tr_b16 v[120:121], v208 offset:61280
    ds_read_b64_tr_b16 v[122:123], v208 offset:62176
    s_waitcnt lgkmcnt(14)
    v_mfma_f32_16x16x32_bf16 v[148:151], v[92:95], v[16:19], v[148:151]
    v_mfma_f32_16x16x32_bf16 v[176:179], v[92:95], v[20:23], v[176:179]
    ds_read_b64_tr_b16 v[124:125], v208 offset:61312
    ds_read_b64_tr_b16 v[126:127], v208 offset:62208
    s_waitcnt lgkmcnt(14)
    v_mfma_f32_16x16x32_bf16 v[152:155], v[96:99], v[16:19], v[152:155]
    v_mfma_f32_16x16x32_bf16 v[180:183], v[96:99], v[20:23], v[180:183]
    ds_read_b64_tr_b16 v[128:129], v208 offset:61344
    ds_read_b64_tr_b16 v[130:131], v208 offset:62240
    s_waitcnt lgkmcnt(14)
    v_mfma_f32_16x16x32_bf16 v[156:159], v[100:103], v[16:19], v[156:159]
    v_mfma_f32_16x16x32_bf16 v[184:187], v[100:103], v[20:23], v[184:187]
    ds_read_b64_tr_b16 v[132:133], v208 offset:61376
    ds_read_b64_tr_b16 v[134:135], v208 offset:62272
    s_waitcnt lgkmcnt(14)
    v_mfma_f32_16x16x32_bf16 v[160:163], v[104:107], v[16:19], v[160:163]
    v_mfma_f32_16x16x32_bf16 v[188:191], v[104:107], v[20:23], v[188:191]
    s_waitcnt lgkmcnt(0)
    s_barrier
    s_waitcnt vmcnt(20)
    ds_read_b64_tr_b16 v[80:81], v208 offset:0
    ds_read_b64_tr_b16 v[82:83], v208 offset:896
    v_mfma_f32_16x16x32_bf16 v[136:139], v[108:111], v[24:27], v[136:139]
    v_mfma_f32_16x16x32_bf16 v[164:167], v[108:111], v[28:31], v[164:167]
    ds_read_b64_tr_b16 v[84:85], v208 offset:32
    ds_read_b64_tr_b16 v[86:87], v208 offset:928
    v_mfma_f32_16x16x32_bf16 v[140:143], v[112:115], v[24:27], v[140:143]
    v_mfma_f32_16x16x32_bf16 v[168:171], v[112:115], v[28:31], v[168:171]
    ds_read_b64_tr_b16 v[88:89], v208 offset:64
    ds_read_b64_tr_b16 v[90:91], v208 offset:960
    v_mfma_f32_16x16x32_bf16 v[144:147], v[116:119], v[24:27], v[144:147]
    v_mfma_f32_16x16x32_bf16 v[172:175], v[116:119], v[28:31], v[172:175]
    ds_read_b64_tr_b16 v[92:93], v208 offset:96
    ds_read_b64_tr_b16 v[94:95], v208 offset:992
    v_mfma_f32_16x16x32_bf16 v[148:151], v[120:123], v[24:27], v[148:151]
    v_mfma_f32_16x16x32_bf16 v[176:179], v[120:123], v[28:31], v[176:179]
    ds_read_b64_tr_b16 v[96:97], v208 offset:128
    ds_read_b64_tr_b16 v[98:99], v208 offset:1024
    v_mfma_f32_16x16x32_bf16 v[152:155], v[124:127], v[24:27], v[152:155]
    v_mfma_f32_16x16x32_bf16 v[180:183], v[124:127], v[28:31], v[180:183]
    ds_read_b64_tr_b16 v[100:101], v208 offset:160
    ds_read_b64_tr_b16 v[102:103], v208 offset:1056
    v_mfma_f32_16x16x32_bf16 v[156:159], v[128:131], v[24:27], v[156:159]
    v_mfma_f32_16x16x32_bf16 v[184:187], v[128:131], v[28:31], v[184:187]
    ds_read_b64_tr_b16 v[104:105], v208 offset:192
    ds_read_b64_tr_b16 v[106:107], v208 offset:1088
    v_mfma_f32_16x16x32_bf16 v[160:163], v[132:135], v[24:27], v[160:163]
    v_mfma_f32_16x16x32_bf16 v[188:191], v[132:135], v[28:31], v[188:191]
    s_waitcnt vmcnt(14)
    ds_read_b64_tr_b16 v[108:109], v208 offset:1792
    ds_read_b64_tr_b16 v[110:111], v208 offset:2688
    s_waitcnt lgkmcnt(14)
    v_mfma_f32_16x16x32_bf16 v[136:139], v[80:83], v[32:35], v[136:139]
    v_mfma_f32_16x16x32_bf16 v[164:167], v[80:83], v[36:39], v[164:167]
    ds_read_b64_tr_b16 v[112:113], v208 offset:1824
    ds_read_b64_tr_b16 v[114:115], v208 offset:2720
    s_waitcnt lgkmcnt(14)
    v_mfma_f32_16x16x32_bf16 v[140:143], v[84:87], v[32:35], v[140:143]
    v_mfma_f32_16x16x32_bf16 v[168:171], v[84:87], v[36:39], v[168:171]
    ds_read_b64_tr_b16 v[116:117], v208 offset:1856
    ds_read_b64_tr_b16 v[118:119], v208 offset:2752
    s_waitcnt lgkmcnt(14)
    v_mfma_f32_16x16x32_bf16 v[144:147], v[88:91], v[32:35], v[144:147]
    v_mfma_f32_16x16x32_bf16 v[172:175], v[88:91], v[36:39], v[172:175]
    ds_read_b64_tr_b16 v[120:121], v208 offset:1888
    ds_read_b64_tr_b16 v[122:123], v208 offset:2784
    s_waitcnt lgkmcnt(14)
    v_mfma_f32_16x16x32_bf16 v[148:151], v[92:95], v[32:35], v[148:151]
    v_mfma_f32_16x16x32_bf16 v[176:179], v[92:95], v[36:39], v[176:179]
    ds_read_b64_tr_b16 v[124:125], v208 offset:1920
    ds_read_b64_tr_b16 v[126:127], v208 offset:2816
    s_waitcnt lgkmcnt(14)
    v_mfma_f32_16x16x32_bf16 v[152:155], v[96:99], v[32:35], v[152:155]
    v_mfma_f32_16x16x32_bf16 v[180:183], v[96:99], v[36:39], v[180:183]
    ds_read_b64_tr_b16 v[128:129], v208 offset:1952
    ds_read_b64_tr_b16 v[130:131], v208 offset:2848
    s_waitcnt lgkmcnt(14)
    v_mfma_f32_16x16x32_bf16 v[156:159], v[100:103], v[32:35], v[156:159]
    v_mfma_f32_16x16x32_bf16 v[184:187], v[100:103], v[36:39], v[184:187]
    ds_read_b64_tr_b16 v[132:133], v208 offset:1984
    ds_read_b64_tr_b16 v[134:135], v208 offset:2880
    s_waitcnt lgkmcnt(14)
    v_mfma_f32_16x16x32_bf16 v[160:163], v[104:107], v[32:35], v[160:163]
    v_mfma_f32_16x16x32_bf16 v[188:191], v[104:107], v[36:39], v[188:191]
    s_waitcnt lgkmcnt(0)
    s_barrier
    s_waitcnt vmcnt(12)
    ds_read_b64_tr_b16 v[80:81], v208 offset:14848
    ds_read_b64_tr_b16 v[82:83], v208 offset:15744
    v_mfma_f32_16x16x32_bf16 v[136:139], v[108:111], v[40:43], v[136:139]
    v_mfma_f32_16x16x32_bf16 v[164:167], v[108:111], v[44:47], v[164:167]
    ds_read_b64_tr_b16 v[84:85], v208 offset:14880
    ds_read_b64_tr_b16 v[86:87], v208 offset:15776
    v_mfma_f32_16x16x32_bf16 v[140:143], v[112:115], v[40:43], v[140:143]
    v_mfma_f32_16x16x32_bf16 v[168:171], v[112:115], v[44:47], v[168:171]
    ds_read_b64_tr_b16 v[88:89], v208 offset:14912
    ds_read_b64_tr_b16 v[90:91], v208 offset:15808
    v_mfma_f32_16x16x32_bf16 v[144:147], v[116:119], v[40:43], v[144:147]
    v_mfma_f32_16x16x32_bf16 v[172:175], v[116:119], v[44:47], v[172:175]
    ds_read_b64_tr_b16 v[92:93], v208 offset:14944
    ds_read_b64_tr_b16 v[94:95], v208 offset:15840
    v_mfma_f32_16x16x32_bf16 v[148:151], v[120:123], v[40:43], v[148:151]
    v_mfma_f32_16x16x32_bf16 v[176:179], v[120:123], v[44:47], v[176:179]
    ds_read_b64_tr_b16 v[96:97], v208 offset:14976
    ds_read_b64_tr_b16 v[98:99], v208 offset:15872
    v_mfma_f32_16x16x32_bf16 v[152:155], v[124:127], v[40:43], v[152:155]
    v_mfma_f32_16x16x32_bf16 v[180:183], v[124:127], v[44:47], v[180:183]
    ds_read_b64_tr_b16 v[100:101], v208 offset:15008
    ds_read_b64_tr_b16 v[102:103], v208 offset:15904
    v_mfma_f32_16x16x32_bf16 v[156:159], v[128:131], v[40:43], v[156:159]
    v_mfma_f32_16x16x32_bf16 v[184:187], v[128:131], v[44:47], v[184:187]
    ds_read_b64_tr_b16 v[104:105], v208 offset:15040
    ds_read_b64_tr_b16 v[106:107], v208 offset:15936
    v_mfma_f32_16x16x32_bf16 v[160:163], v[132:135], v[40:43], v[160:163]
    v_mfma_f32_16x16x32_bf16 v[188:191], v[132:135], v[44:47], v[188:191]
    s_waitcnt vmcnt(6)
    ds_read_b64_tr_b16 v[108:109], v208 offset:16640
    ds_read_b64_tr_b16 v[110:111], v208 offset:17536
    s_waitcnt lgkmcnt(14)
    v_mfma_f32_16x16x32_bf16 v[136:139], v[80:83], v[48:51], v[136:139]
    v_mfma_f32_16x16x32_bf16 v[164:167], v[80:83], v[52:55], v[164:167]
    ds_read_b64_tr_b16 v[112:113], v208 offset:16672
    ds_read_b64_tr_b16 v[114:115], v208 offset:17568
    s_waitcnt lgkmcnt(14)
    v_mfma_f32_16x16x32_bf16 v[140:143], v[84:87], v[48:51], v[140:143]
    v_mfma_f32_16x16x32_bf16 v[168:171], v[84:87], v[52:55], v[168:171]
    ds_read_b64_tr_b16 v[116:117], v208 offset:16704
    ds_read_b64_tr_b16 v[118:119], v208 offset:17600
    s_waitcnt lgkmcnt(14)
    v_mfma_f32_16x16x32_bf16 v[144:147], v[88:91], v[48:51], v[144:147]
    v_mfma_f32_16x16x32_bf16 v[172:175], v[88:91], v[52:55], v[172:175]
    ds_read_b64_tr_b16 v[120:121], v208 offset:16736
    ds_read_b64_tr_b16 v[122:123], v208 offset:17632
    s_waitcnt lgkmcnt(14)
    v_mfma_f32_16x16x32_bf16 v[148:151], v[92:95], v[48:51], v[148:151]
    v_mfma_f32_16x16x32_bf16 v[176:179], v[92:95], v[52:55], v[176:179]
    ds_read_b64_tr_b16 v[124:125], v208 offset:16768
    ds_read_b64_tr_b16 v[126:127], v208 offset:17664
    s_waitcnt lgkmcnt(14)
    v_mfma_f32_16x16x32_bf16 v[152:155], v[96:99], v[48:51], v[152:155]
    v_mfma_f32_16x16x32_bf16 v[180:183], v[96:99], v[52:55], v[180:183]
    ds_read_b64_tr_b16 v[128:129], v208 offset:16800
    ds_read_b64_tr_b16 v[130:131], v208 offset:17696
    s_waitcnt lgkmcnt(14)
    v_mfma_f32_16x16x32_bf16 v[156:159], v[100:103], v[48:51], v[156:159]
    v_mfma_f32_16x16x32_bf16 v[184:187], v[100:103], v[52:55], v[184:187]
    ds_read_b64_tr_b16 v[132:133], v208 offset:16832
    ds_read_b64_tr_b16 v[134:135], v208 offset:17728
    s_waitcnt lgkmcnt(14)
    v_mfma_f32_16x16x32_bf16 v[160:163], v[104:107], v[48:51], v[160:163]
    v_mfma_f32_16x16x32_bf16 v[188:191], v[104:107], v[52:55], v[188:191]
    s_waitcnt lgkmcnt(0)
    s_barrier
    s_waitcnt vmcnt(4)
    ds_read_b64_tr_b16 v[80:81], v208 offset:29696
    ds_read_b64_tr_b16 v[82:83], v208 offset:30592
    v_mfma_f32_16x16x32_bf16 v[136:139], v[108:111], v[56:59], v[136:139]
    v_mfma_f32_16x16x32_bf16 v[164:167], v[108:111], v[60:63], v[164:167]
    ds_read_b64_tr_b16 v[84:85], v208 offset:29728
    ds_read_b64_tr_b16 v[86:87], v208 offset:30624
    v_mfma_f32_16x16x32_bf16 v[140:143], v[112:115], v[56:59], v[140:143]
    v_mfma_f32_16x16x32_bf16 v[168:171], v[112:115], v[60:63], v[168:171]
    ds_read_b64_tr_b16 v[88:89], v208 offset:29760
    ds_read_b64_tr_b16 v[90:91], v208 offset:30656
    v_mfma_f32_16x16x32_bf16 v[144:147], v[116:119], v[56:59], v[144:147]
    v_mfma_f32_16x16x32_bf16 v[172:175], v[116:119], v[60:63], v[172:175]
    ds_read_b64_tr_b16 v[92:93], v208 offset:29792
    ds_read_b64_tr_b16 v[94:95], v208 offset:30688
    v_mfma_f32_16x16x32_bf16 v[148:151], v[120:123], v[56:59], v[148:151]
    v_mfma_f32_16x16x32_bf16 v[176:179], v[120:123], v[60:63], v[176:179]
    ds_read_b64_tr_b16 v[96:97], v208 offset:29824
    ds_read_b64_tr_b16 v[98:99], v208 offset:30720
    v_mfma_f32_16x16x32_bf16 v[152:155], v[124:127], v[56:59], v[152:155]
    v_mfma_f32_16x16x32_bf16 v[180:183], v[124:127], v[60:63], v[180:183]
    ds_read_b64_tr_b16 v[100:101], v208 offset:29856
    ds_read_b64_tr_b16 v[102:103], v208 offset:30752
    v_mfma_f32_16x16x32_bf16 v[156:159], v[128:131], v[56:59], v[156:159]
    v_mfma_f32_16x16x32_bf16 v[184:187], v[128:131], v[60:63], v[184:187]
    ds_read_b64_tr_b16 v[104:105], v208 offset:29888
    ds_read_b64_tr_b16 v[106:107], v208 offset:30784
    v_mfma_f32_16x16x32_bf16 v[160:163], v[132:135], v[56:59], v[160:163]
    v_mfma_f32_16x16x32_bf16 v[188:191], v[132:135], v[60:63], v[188:191]
    s_waitcnt vmcnt(2)
    ds_read_b64_tr_b16 v[108:109], v208 offset:31488
    ds_read_b64_tr_b16 v[110:111], v208 offset:32384
    s_waitcnt lgkmcnt(14)
    v_mfma_f32_16x16x32_bf16 v[136:139], v[80:83], v[64:67], v[136:139]
    v_mfma_f32_16x16x32_bf16 v[164:167], v[80:83], v[68:71], v[164:167]
    ds_read_b64_tr_b16 v[112:113], v208 offset:31520
    ds_read_b64_tr_b16 v[114:115], v208 offset:32416
    s_waitcnt lgkmcnt(14)
    v_mfma_f32_16x16x32_bf16 v[140:143], v[84:87], v[64:67], v[140:143]
    v_mfma_f32_16x16x32_bf16 v[168:171], v[84:87], v[68:71], v[168:171]
    ds_read_b64_tr_b16 v[116:117], v208 offset:31552
    ds_read_b64_tr_b16 v[118:119], v208 offset:32448
    s_waitcnt lgkmcnt(14)
    v_mfma_f32_16x16x32_bf16 v[144:147], v[88:91], v[64:67], v[144:147]
    v_mfma_f32_16x16x32_bf16 v[172:175], v[88:91], v[68:71], v[172:175]
    ds_read_b64_tr_b16 v[120:121], v208 offset:31584
    ds_read_b64_tr_b16 v[122:123], v208 offset:32480
    s_waitcnt lgkmcnt(14)
    v_mfma_f32_16x16x32_bf16 v[148:151], v[92:95], v[64:67], v[148:151]
    v_mfma_f32_16x16x32_bf16 v[176:179], v[92:95], v[68:71], v[176:179]
    ds_read_b64_tr_b16 v[124:125], v208 offset:31616
    ds_read_b64_tr_b16 v[126:127], v208 offset:32512
    s_waitcnt lgkmcnt(14)
    v_mfma_f32_16x16x32_bf16 v[152:155], v[96:99], v[64:67], v[152:155]
    v_mfma_f32_16x16x32_bf16 v[180:183], v[96:99], v[68:71], v[180:183]
    ds_read_b64_tr_b16 v[128:129], v208 offset:31648
    ds_read_b64_tr_b16 v[130:131], v208 offset:32544
    s_waitcnt lgkmcnt(14)
    v_mfma_f32_16x16x32_bf16 v[156:159], v[100:103], v[64:67], v[156:159]
    v_mfma_f32_16x16x32_bf16 v[184:187], v[100:103], v[68:71], v[184:187]
    ds_read_b64_tr_b16 v[132:133], v208 offset:31680
    ds_read_b64_tr_b16 v[134:135], v208 offset:32576
    s_waitcnt lgkmcnt(14)
    v_mfma_f32_16x16x32_bf16 v[160:163], v[104:107], v[64:67], v[160:163]
    v_mfma_f32_16x16x32_bf16 v[188:191], v[104:107], v[68:71], v[188:191]
    s_waitcnt vmcnt(0)
    s_waitcnt lgkmcnt(12)
    v_mfma_f32_16x16x32_bf16 v[136:139], v[108:111], v[72:75], v[136:139]
    v_mfma_f32_16x16x32_bf16 v[164:167], v[108:111], v[76:79], v[164:167]
    s_waitcnt lgkmcnt(10)
    v_mfma_f32_16x16x32_bf16 v[140:143], v[112:115], v[72:75], v[140:143]
    v_mfma_f32_16x16x32_bf16 v[168:171], v[112:115], v[76:79], v[168:171]
    s_waitcnt lgkmcnt(8)
    v_mfma_f32_16x16x32_bf16 v[144:147], v[116:119], v[72:75], v[144:147]
    v_mfma_f32_16x16x32_bf16 v[172:175], v[116:119], v[76:79], v[172:175]
    s_waitcnt lgkmcnt(6)
    v_mfma_f32_16x16x32_bf16 v[148:151], v[120:123], v[72:75], v[148:151]
    v_mfma_f32_16x16x32_bf16 v[176:179], v[120:123], v[76:79], v[176:179]
    s_waitcnt lgkmcnt(4)
    v_mfma_f32_16x16x32_bf16 v[152:155], v[124:127], v[72:75], v[152:155]
    v_mfma_f32_16x16x32_bf16 v[180:183], v[124:127], v[76:79], v[180:183]
    s_waitcnt lgkmcnt(2)
    v_mfma_f32_16x16x32_bf16 v[156:159], v[128:131], v[72:75], v[156:159]
    v_mfma_f32_16x16x32_bf16 v[184:187], v[128:131], v[76:79], v[184:187]
    s_waitcnt lgkmcnt(0)
    v_mfma_f32_16x16x32_bf16 v[160:163], v[132:135], v[72:75], v[160:163]
    v_mfma_f32_16x16x32_bf16 v[188:191], v[132:135], v[76:79], v[188:191]
    s_mov_b32 s8, s60
    s_mov_b32 s9, s61
    s_mov_b32 s47, s46
    s_waitcnt lgkmcnt(0)
    s_barrier
    s_mov_b32 s64, s46
    s_add_u32 s46, s46, 1
    s_cmp_ge_u32 s46, 14
    s_cselect_b32 s46, 0, s46
    s_lshl_b32 s52, s64, 17
    s_add_u32 s50, s45, 0
    s_mov_b32 m0, s50
    s_add_u32 s51, s52, 0
    buffer_load_dwordx4 v212, s[8:11], s51 offen lds
    s_add_u32 s50, s45, 1024
    s_mov_b32 m0, s50
    s_add_u32 s51, s52, 8192
    buffer_load_dwordx4 v213, s[8:11], s51 offen lds
    s_add_u32 s50, s45, 2048
    s_mov_b32 m0, s50
    s_add_u32 s51, s52, 16384
    buffer_load_dwordx4 v212, s[8:11], s51 offen lds
    s_add_u32 s50, s45, 3072
    s_mov_b32 m0, s50
    s_add_u32 s51, s52, 24576
    buffer_load_dwordx4 v213, s[8:11], s51 offen lds
    s_mov_b32 s65, s46
    s_add_u32 s46, s46, 1
    s_cmp_ge_u32 s46, 14
    s_cselect_b32 s46, 0, s46
    s_lshl_b32 s52, s65, 17
    s_add_u32 s50, s45, 16384
    s_mov_b32 m0, s50
    s_add_u32 s51, s52, 0
    buffer_load_dwordx4 v212, s[8:11], s51 offen lds
    s_add_u32 s50, s45, 17408
    s_mov_b32 m0, s50
    s_add_u32 s51, s52, 8192
    buffer_load_dwordx4 v213, s[8:11], s51 offen lds
    s_add_u32 s50, s45, 18432
    s_mov_b32 m0, s50
    s_add_u32 s51, s52, 16384
    buffer_load_dwordx4 v212, s[8:11], s51 offen lds
    s_add_u32 s50, s45, 19456
    s_mov_b32 m0, s50
    s_add_u32 s51, s52, 24576
    buffer_load_dwordx4 v213, s[8:11], s51 offen lds
    s_mov_b32 s66, s46
    s_add_u32 s46, s46, 1
    s_cmp_ge_u32 s46, 14
    s_cselect_b32 s46, 0, s46
    s_lshl_b32 s52, s66, 17
    s_add_u32 s50, s45, 32768
    s_mov_b32 m0, s50
    s_add_u32 s51, s52, 0
    buffer_load_dwordx4 v212, s[8:11], s51 offen lds
    s_add_u32 s50, s45, 33792
    s_mov_b32 m0, s50
    s_add_u32 s51, s52, 8192
    buffer_load_dwordx4 v213, s[8:11], s51 offen lds
    s_add_u32 s50, s45, 34816
    s_mov_b32 m0, s50
    s_add_u32 s51, s52, 16384
    buffer_load_dwordx4 v212, s[8:11], s51 offen lds
    s_add_u32 s50, s45, 35840
    s_mov_b32 m0, s50
    s_add_u32 s51, s52, 24576
    buffer_load_dwordx4 v213, s[8:11], s51 offen lds
    v_mul_f32 v80, 0x3fb8aa3b, v136
    v_mul_f32 v81, 0x3fb8aa3b, v137
    v_mul_f32 v82, 0x3fb8aa3b, v138
    v_mul_f32 v83, 0x3fb8aa3b, v139
    v_exp_f32 v80, v80
    v_exp_f32 v81, v81
    v_exp_f32 v82, v82
    v_exp_f32 v83, v83
    v_add_f32 v80, 1.0, v80
    v_add_f32 v81, 1.0, v81
    v_add_f32 v82, 1.0, v82
    v_add_f32 v83, 1.0, v83
    v_fma_f32 v80, v80, v80, 1.0
    v_fma_f32 v81, v81, v81, 1.0
    v_fma_f32 v82, v82, v82, 1.0
    v_fma_f32 v83, v83, v83, 1.0
    v_rcp_f32 v80, v80
    v_rcp_f32 v81, v81
    v_rcp_f32 v82, v82
    v_rcp_f32 v83, v83
    v_mul_f32 v80, v136, v80
    v_mul_f32 v81, v137, v81
    v_mul_f32 v82, v138, v82
    v_mul_f32 v83, v139, v83
    v_fma_f32 v136, v80, -2.0, v136
    v_fma_f32 v137, v81, -2.0, v137
    v_fma_f32 v138, v82, -2.0, v138
    v_fma_f32 v139, v83, -2.0, v139
    v_cvt_pk_bf16_f32 v88, v136, v137
    v_cvt_pk_bf16_f32 v89, v138, v139
    v_mul_f32 v84, 0x3fb8aa3b, v140
    v_mul_f32 v85, 0x3fb8aa3b, v141
    v_mul_f32 v86, 0x3fb8aa3b, v142
    v_mul_f32 v87, 0x3fb8aa3b, v143
    v_exp_f32 v84, v84
    v_exp_f32 v85, v85
    v_exp_f32 v86, v86
    v_exp_f32 v87, v87
    v_add_f32 v84, 1.0, v84
    v_add_f32 v85, 1.0, v85
    v_add_f32 v86, 1.0, v86
    v_add_f32 v87, 1.0, v87
    v_fma_f32 v84, v84, v84, 1.0
    v_fma_f32 v85, v85, v85, 1.0
    v_fma_f32 v86, v86, v86, 1.0
    v_fma_f32 v87, v87, v87, 1.0
    v_rcp_f32 v84, v84
    v_rcp_f32 v85, v85
    v_rcp_f32 v86, v86
    v_rcp_f32 v87, v87
    v_mul_f32 v84, v140, v84
    v_mul_f32 v85, v141, v85
    v_mul_f32 v86, v142, v86
    v_mul_f32 v87, v143, v87
    v_fma_f32 v140, v84, -2.0, v140
    v_fma_f32 v141, v85, -2.0, v141
    v_fma_f32 v142, v86, -2.0, v142
    v_fma_f32 v143, v87, -2.0, v143
    v_cvt_pk_bf16_f32 v90, v140, v141
    v_cvt_pk_bf16_f32 v91, v142, v143
    s_nop 0
    v_permlane16_swap_b32 v88, v90
    v_permlane16_swap_b32 v89, v91
    global_store_dwordx4 v209, v[88:91], s[4:5] offset:0 sc1
    v_mul_f32 v80, 0x3fb8aa3b, v144
    v_mul_f32 v81, 0x3fb8aa3b, v145
    v_mul_f32 v82, 0x3fb8aa3b, v146
    v_mul_f32 v83, 0x3fb8aa3b, v147
    v_exp_f32 v80, v80
    v_exp_f32 v81, v81
    v_exp_f32 v82, v82
    v_exp_f32 v83, v83
    v_add_f32 v80, 1.0, v80
    v_add_f32 v81, 1.0, v81
    v_add_f32 v82, 1.0, v82
    v_add_f32 v83, 1.0, v83
    v_fma_f32 v80, v80, v80, 1.0
    v_fma_f32 v81, v81, v81, 1.0
    v_fma_f32 v82, v82, v82, 1.0
    v_fma_f32 v83, v83, v83, 1.0
    v_rcp_f32 v80, v80
    v_rcp_f32 v81, v81
    v_rcp_f32 v82, v82
    v_rcp_f32 v83, v83
    v_mul_f32 v80, v144, v80
    v_mul_f32 v81, v145, v81
    v_mul_f32 v82, v146, v82
    v_mul_f32 v83, v147, v83
    v_fma_f32 v144, v80, -2.0, v144
    v_fma_f32 v145, v81, -2.0, v145
    v_fma_f32 v146, v82, -2.0, v146
    v_fma_f32 v147, v83, -2.0, v147
    v_cvt_pk_bf16_f32 v92, v144, v145
    v_cvt_pk_bf16_f32 v93, v146, v147
    v_mul_f32 v84, 0x3fb8aa3b, v148
    v_mul_f32 v85, 0x3fb8aa3b, v149
    v_mul_f32 v86, 0x3fb8aa3b, v150
    v_mul_f32 v87, 0x3fb8aa3b, v151
    v_exp_f32 v84, v84
    v_exp_f32 v85, v85
    v_exp_f32 v86, v86
    v_exp_f32 v87, v87
    v_add_f32 v84, 1.0, v84
    v_add_f32 v85, 1.0, v85
    v_add_f32 v86, 1.0, v86
    v_add_f32 v87, 1.0, v87
    v_fma_f32 v84, v84, v84, 1.0
    v_fma_f32 v85, v85, v85, 1.0
    v_fma_f32 v86, v86, v86, 1.0
    v_fma_f32 v87, v87, v87, 1.0
    v_rcp_f32 v84, v84
    v_rcp_f32 v85, v85
    v_rcp_f32 v86, v86
    v_rcp_f32 v87, v87
    v_mul_f32 v84, v148, v84
    v_mul_f32 v85, v149, v85
    v_mul_f32 v86, v150, v86
    v_mul_f32 v87, v151, v87
    v_fma_f32 v148, v84, -2.0, v148
    v_fma_f32 v149, v85, -2.0, v149
    v_fma_f32 v150, v86, -2.0, v150
    v_fma_f32 v151, v87, -2.0, v151
    v_cvt_pk_bf16_f32 v94, v148, v149
    v_cvt_pk_bf16_f32 v95, v150, v151
    s_nop 0
    v_permlane16_swap_b32 v92, v94
    v_permlane16_swap_b32 v93, v95
    global_store_dwordx4 v209, v[92:95], s[4:5] offset:1024 sc1
    v_mul_f32 v80, 0x3fb8aa3b, v152
    v_mul_f32 v81, 0x3fb8aa3b, v153
    v_mul_f32 v82, 0x3fb8aa3b, v154
    v_mul_f32 v83, 0x3fb8aa3b, v155
    v_exp_f32 v80, v80
    v_exp_f32 v81, v81
    v_exp_f32 v82, v82
    v_exp_f32 v83, v83
    v_add_f32 v80, 1.0, v80
    v_add_f32 v81, 1.0, v81
    v_add_f32 v82, 1.0, v82
    v_add_f32 v83, 1.0, v83
    v_fma_f32 v80, v80, v80, 1.0
    v_fma_f32 v81, v81, v81, 1.0
    v_fma_f32 v82, v82, v82, 1.0
    v_fma_f32 v83, v83, v83, 1.0
    v_rcp_f32 v80, v80
    v_rcp_f32 v81, v81
    v_rcp_f32 v82, v82
    v_rcp_f32 v83, v83
    v_mul_f32 v80, v152, v80
    v_mul_f32 v81, v153, v81
    v_mul_f32 v82, v154, v82
    v_mul_f32 v83, v155, v83
    v_fma_f32 v152, v80, -2.0, v152
    v_fma_f32 v153, v81, -2.0, v153
    v_fma_f32 v154, v82, -2.0, v154
    v_fma_f32 v155, v83, -2.0, v155
    v_cvt_pk_bf16_f32 v88, v152, v153
    v_cvt_pk_bf16_f32 v89, v154, v155
    v_mul_f32 v84, 0x3fb8aa3b, v156
    v_mul_f32 v85, 0x3fb8aa3b, v157
    v_mul_f32 v86, 0x3fb8aa3b, v158
    v_mul_f32 v87, 0x3fb8aa3b, v159
    v_exp_f32 v84, v84
    v_exp_f32 v85, v85
    v_exp_f32 v86, v86
    v_exp_f32 v87, v87
    v_add_f32 v84, 1.0, v84
    v_add_f32 v85, 1.0, v85
    v_add_f32 v86, 1.0, v86
    v_add_f32 v87, 1.0, v87
    v_fma_f32 v84, v84, v84, 1.0
    v_fma_f32 v85, v85, v85, 1.0
    v_fma_f32 v86, v86, v86, 1.0
    v_fma_f32 v87, v87, v87, 1.0
    v_rcp_f32 v84, v84
    v_rcp_f32 v85, v85
    v_rcp_f32 v86, v86
    v_rcp_f32 v87, v87
    v_mul_f32 v84, v156, v84
    v_mul_f32 v85, v157, v85
    v_mul_f32 v86, v158, v86
    v_mul_f32 v87, v159, v87
    v_fma_f32 v156, v84, -2.0, v156
    v_fma_f32 v157, v85, -2.0, v157
    v_fma_f32 v158, v86, -2.0, v158
    v_fma_f32 v159, v87, -2.0, v159
    v_cvt_pk_bf16_f32 v90, v156, v157
    v_cvt_pk_bf16_f32 v91, v158, v159
    s_nop 0
    v_permlane16_swap_b32 v88, v90
    v_permlane16_swap_b32 v89, v91
    global_store_dwordx4 v209, v[88:91], s[4:5] offset:2048 sc1
    v_mul_f32 v80, 0x3fb8aa3b, v160
    v_mul_f32 v81, 0x3fb8aa3b, v161
    v_mul_f32 v82, 0x3fb8aa3b, v162
    v_mul_f32 v83, 0x3fb8aa3b, v163
    v_exp_f32 v80, v80
    v_exp_f32 v81, v81
    v_exp_f32 v82, v82
    v_exp_f32 v83, v83
    v_add_f32 v80, 1.0, v80
    v_add_f32 v81, 1.0, v81
    v_add_f32 v82, 1.0, v82
    v_add_f32 v83, 1.0, v83
    v_fma_f32 v80, v80, v80, 1.0
    v_fma_f32 v81, v81, v81, 1.0
    v_fma_f32 v82, v82, v82, 1.0
    v_fma_f32 v83, v83, v83, 1.0
    v_rcp_f32 v80, v80
    v_rcp_f32 v81, v81
    v_rcp_f32 v82, v82
    v_rcp_f32 v83, v83
    v_mul_f32 v80, v160, v80
    v_mul_f32 v81, v161, v81
    v_mul_f32 v82, v162, v82
    v_mul_f32 v83, v163, v83
    v_fma_f32 v160, v80, -2.0, v160
    v_fma_f32 v161, v81, -2.0, v161
    v_fma_f32 v162, v82, -2.0, v162
    v_fma_f32 v163, v83, -2.0, v163
    v_cvt_pk_bf16_f32 v92, v160, v161
    v_cvt_pk_bf16_f32 v93, v162, v163
    global_store_dwordx2 v210, v[92:93], s[4:5] offset:3072 sc1
    v_add_u32 v209, 57344, v209
    v_add_u32 v210, 57344, v210
    v_mul_f32 v80, 0x3fb8aa3b, v164
    v_mul_f32 v81, 0x3fb8aa3b, v165
    v_mul_f32 v82, 0x3fb8aa3b, v166
    v_mul_f32 v83, 0x3fb8aa3b, v167
    v_exp_f32 v80, v80
    v_exp_f32 v81, v81
    v_exp_f32 v82, v82
    v_exp_f32 v83, v83
    v_add_f32 v80, 1.0, v80
    v_add_f32 v81, 1.0, v81
    v_add_f32 v82, 1.0, v82
    v_add_f32 v83, 1.0, v83
    v_fma_f32 v80, v80, v80, 1.0
    v_fma_f32 v81, v81, v81, 1.0
    v_fma_f32 v82, v82, v82, 1.0
    v_fma_f32 v83, v83, v83, 1.0
    v_rcp_f32 v80, v80
    v_rcp_f32 v81, v81
    v_rcp_f32 v82, v82
    v_rcp_f32 v83, v83
    v_mul_f32 v80, v164, v80
    v_mul_f32 v81, v165, v81
    v_mul_f32 v82, v166, v82
    v_mul_f32 v83, v167, v83
    v_fma_f32 v164, v80, -2.0, v164
    v_fma_f32 v165, v81, -2.0, v165
    v_fma_f32 v166, v82, -2.0, v166
    v_fma_f32 v167, v83, -2.0, v167
    v_cvt_pk_bf16_f32 v88, v164, v165
    v_cvt_pk_bf16_f32 v89, v166, v167
    v_mul_f32 v84, 0x3fb8aa3b, v168
    v_mul_f32 v85, 0x3fb8aa3b, v169
    v_mul_f32 v86, 0x3fb8aa3b, v170
    v_mul_f32 v87, 0x3fb8aa3b, v171
    v_exp_f32 v84, v84
    v_exp_f32 v85, v85
    v_exp_f32 v86, v86
    v_exp_f32 v87, v87
    v_add_f32 v84, 1.0, v84
    v_add_f32 v85, 1.0, v85
    v_add_f32 v86, 1.0, v86
    v_add_f32 v87, 1.0, v87
    v_fma_f32 v84, v84, v84, 1.0
    v_fma_f32 v85, v85, v85, 1.0
    v_fma_f32 v86, v86, v86, 1.0
    v_fma_f32 v87, v87, v87, 1.0
    v_rcp_f32 v84, v84
    v_rcp_f32 v85, v85
    v_rcp_f32 v86, v86
    v_rcp_f32 v87, v87
    v_mul_f32 v84, v168, v84
    v_mul_f32 v85, v169, v85
    v_mul_f32 v86, v170, v86
    v_mul_f32 v87, v171, v87
    v_fma_f32 v168, v84, -2.0, v168
    v_fma_f32 v169, v85, -2.0, v169
    v_fma_f32 v170, v86, -2.0, v170
    v_fma_f32 v171, v87, -2.0, v171
    v_cvt_pk_bf16_f32 v90, v168, v169
    v_cvt_pk_bf16_f32 v91, v170, v171
    s_nop 0
    v_permlane16_swap_b32 v88, v90
    v_permlane16_swap_b32 v89, v91
    global_store_dwordx4 v209, v[88:91], s[4:5] offset:0 sc1
    v_mul_f32 v80, 0x3fb8aa3b, v172
    v_mul_f32 v81, 0x3fb8aa3b, v173
    v_mul_f32 v82, 0x3fb8aa3b, v174
    v_mul_f32 v83, 0x3fb8aa3b, v175
    v_exp_f32 v80, v80
    v_exp_f32 v81, v81
    v_exp_f32 v82, v82
    v_exp_f32 v83, v83
    v_add_f32 v80, 1.0, v80
    v_add_f32 v81, 1.0, v81
    v_add_f32 v82, 1.0, v82
    v_add_f32 v83, 1.0, v83
    v_fma_f32 v80, v80, v80, 1.0
    v_fma_f32 v81, v81, v81, 1.0
    v_fma_f32 v82, v82, v82, 1.0
    v_fma_f32 v83, v83, v83, 1.0
    v_rcp_f32 v80, v80
    v_rcp_f32 v81, v81
    v_rcp_f32 v82, v82
    v_rcp_f32 v83, v83
    v_mul_f32 v80, v172, v80
    v_mul_f32 v81, v173, v81
    v_mul_f32 v82, v174, v82
    v_mul_f32 v83, v175, v83
    v_fma_f32 v172, v80, -2.0, v172
    v_fma_f32 v173, v81, -2.0, v173
    v_fma_f32 v174, v82, -2.0, v174
    v_fma_f32 v175, v83, -2.0, v175
    v_cvt_pk_bf16_f32 v92, v172, v173
    v_cvt_pk_bf16_f32 v93, v174, v175
    v_mul_f32 v84, 0x3fb8aa3b, v176
    v_mul_f32 v85, 0x3fb8aa3b, v177
    v_mul_f32 v86, 0x3fb8aa3b, v178
    v_mul_f32 v87, 0x3fb8aa3b, v179
    v_exp_f32 v84, v84
    v_exp_f32 v85, v85
    v_exp_f32 v86, v86
    v_exp_f32 v87, v87
    v_add_f32 v84, 1.0, v84
    v_add_f32 v85, 1.0, v85
    v_add_f32 v86, 1.0, v86
    v_add_f32 v87, 1.0, v87
    v_fma_f32 v84, v84, v84, 1.0
    v_fma_f32 v85, v85, v85, 1.0
    v_fma_f32 v86, v86, v86, 1.0
    v_fma_f32 v87, v87, v87, 1.0
    v_rcp_f32 v84, v84
    v_rcp_f32 v85, v85
    v_rcp_f32 v86, v86
    v_rcp_f32 v87, v87
    v_mul_f32 v84, v176, v84
    v_mul_f32 v85, v177, v85
    v_mul_f32 v86, v178, v86
    v_mul_f32 v87, v179, v87
    v_fma_f32 v176, v84, -2.0, v176
    v_fma_f32 v177, v85, -2.0, v177
    v_fma_f32 v178, v86, -2.0, v178
    v_fma_f32 v179, v87, -2.0, v179
    v_cvt_pk_bf16_f32 v94, v176, v177
    v_cvt_pk_bf16_f32 v95, v178, v179
    s_nop 0
    v_permlane16_swap_b32 v92, v94
    v_permlane16_swap_b32 v93, v95
    global_store_dwordx4 v209, v[92:95], s[4:5] offset:1024 sc1
    v_mul_f32 v80, 0x3fb8aa3b, v180
    v_mul_f32 v81, 0x3fb8aa3b, v181
    v_mul_f32 v82, 0x3fb8aa3b, v182
    v_mul_f32 v83, 0x3fb8aa3b, v183
    v_exp_f32 v80, v80
    v_exp_f32 v81, v81
    v_exp_f32 v82, v82
    v_exp_f32 v83, v83
    v_add_f32 v80, 1.0, v80
    v_add_f32 v81, 1.0, v81
    v_add_f32 v82, 1.0, v82
    v_add_f32 v83, 1.0, v83
    v_fma_f32 v80, v80, v80, 1.0
    v_fma_f32 v81, v81, v81, 1.0
    v_fma_f32 v82, v82, v82, 1.0
    v_fma_f32 v83, v83, v83, 1.0
    v_rcp_f32 v80, v80
    v_rcp_f32 v81, v81
    v_rcp_f32 v82, v82
    v_rcp_f32 v83, v83
    v_mul_f32 v80, v180, v80
    v_mul_f32 v81, v181, v81
    v_mul_f32 v82, v182, v82
    v_mul_f32 v83, v183, v83
    v_fma_f32 v180, v80, -2.0, v180
    v_fma_f32 v181, v81, -2.0, v181
    v_fma_f32 v182, v82, -2.0, v182
    v_fma_f32 v183, v83, -2.0, v183
    v_cvt_pk_bf16_f32 v88, v180, v181
    v_cvt_pk_bf16_f32 v89, v182, v183
    v_mul_f32 v84, 0x3fb8aa3b, v184
    v_mul_f32 v85, 0x3fb8aa3b, v185
    v_mul_f32 v86, 0x3fb8aa3b, v186
    v_mul_f32 v87, 0x3fb8aa3b, v187
    v_exp_f32 v84, v84
    v_exp_f32 v85, v85
    v_exp_f32 v86, v86
    v_exp_f32 v87, v87
    v_add_f32 v84, 1.0, v84
    v_add_f32 v85, 1.0, v85
    v_add_f32 v86, 1.0, v86
    v_add_f32 v87, 1.0, v87
    v_fma_f32 v84, v84, v84, 1.0
    v_fma_f32 v85, v85, v85, 1.0
    v_fma_f32 v86, v86, v86, 1.0
    v_fma_f32 v87, v87, v87, 1.0
    v_rcp_f32 v84, v84
    v_rcp_f32 v85, v85
    v_rcp_f32 v86, v86
    v_rcp_f32 v87, v87
    v_mul_f32 v84, v184, v84
    v_mul_f32 v85, v185, v85
    v_mul_f32 v86, v186, v86
    v_mul_f32 v87, v187, v87
    v_fma_f32 v184, v84, -2.0, v184
    v_fma_f32 v185, v85, -2.0, v185
    v_fma_f32 v186, v86, -2.0, v186
    v_fma_f32 v187, v87, -2.0, v187
    v_cvt_pk_bf16_f32 v90, v184, v185
    v_cvt_pk_bf16_f32 v91, v186, v187
    s_nop 0
    v_permlane16_swap_b32 v88, v90
    v_permlane16_swap_b32 v89, v91
    global_store_dwordx4 v209, v[88:91], s[4:5] offset:2048 sc1
    v_mul_f32 v80, 0x3fb8aa3b, v188
    v_mul_f32 v81, 0x3fb8aa3b, v189
    v_mul_f32 v82, 0x3fb8aa3b, v190
    v_mul_f32 v83, 0x3fb8aa3b, v191
    v_exp_f32 v80, v80
    v_exp_f32 v81, v81
    v_exp_f32 v82, v82
    v_exp_f32 v83, v83
    v_add_f32 v80, 1.0, v80
    v_add_f32 v81, 1.0, v81
    v_add_f32 v82, 1.0, v82
    v_add_f32 v83, 1.0, v83
    v_fma_f32 v80, v80, v80, 1.0
    v_fma_f32 v81, v81, v81, 1.0
    v_fma_f32 v82, v82, v82, 1.0
    v_fma_f32 v83, v83, v83, 1.0
    v_rcp_f32 v80, v80
    v_rcp_f32 v81, v81
    v_rcp_f32 v82, v82
    v_rcp_f32 v83, v83
    v_mul_f32 v80, v188, v80
    v_mul_f32 v81, v189, v81
    v_mul_f32 v82, v190, v82
    v_mul_f32 v83, v191, v83
    v_fma_f32 v188, v80, -2.0, v188
    v_fma_f32 v189, v81, -2.0, v189
    v_fma_f32 v190, v82, -2.0, v190
    v_fma_f32 v191, v83, -2.0, v191
    v_cvt_pk_bf16_f32 v92, v188, v189
    v_cvt_pk_bf16_f32 v93, v190, v191
    global_store_dwordx2 v210, v[92:93], s[4:5] offset:3072 sc1
    s_waitcnt vmcnt(0)
    s_barrier
    s_cmp_lg_u32 s22, 0
    s_cbranch_scc1 L_sig_h
    s_add_u32 s50, s26, 16
    s_lshl_b32 s50, s50, 8
    s_add_u32 s50, s18, s50
    s_addc_u32 s51, s19, 0
    s_mov_b64 exec, 1
    global_atomic_add v250, v251, s[50:51]
    s_mov_b64 exec, -1
    s_lshr_b32 s50, s29, 1
    s_add_u32 s50, s50, 16
    s_lshl_b32 s50, s50, 8
    s_add_u32 s50, s18, s50
    s_addc_u32 s51, s19, 0
    s_mov_b32 s55, 0
L_poll_h_loop:
    global_load_dword v252, v250, s[50:51] sc1
    s_waitcnt vmcnt(0)
    v_readfirstlane_b32 s54, v252
    s_nop 0
    s_cmp_ge_u32 s54, 16
    s_cbranch_scc1 L_poll_h_ok
    s_add_u32 s55, s55, 1
    s_cmp_ge_u32 s55, 0x40000
    s_cbranch_scc1 L_poll_h_ok
    s_sleep 2
    s_branch L_poll_h_loop
L_poll_h_ok:
L_sig_h:
    s_barrier
    s_lshl_b32 s52, s47, 12
    s_add_u32 s47, s47, 1
    s_cmp_ge_u32 s47, 14
    s_cselect_b32 s47, 0, s47
    v_add_u32 v253, s52, v211
    global_load_dwordx4 v[16:19], v253, s[4:5] offset:0 sc1
    global_load_dwordx4 v[20:23], v253, s[4:5] offset:1024 sc1
    global_load_dwordx4 v[24:27], v253, s[4:5] offset:2048 sc1
    global_load_dwordx4 v[28:31], v253, s[4:5] offset:3072 sc1
    s_lshl_b32 s52, s47, 12
    s_add_u32 s47, s47, 1
    s_cmp_ge_u32 s47, 14
    s_cselect_b32 s47, 0, s47
    v_add_u32 v253, s52, v211
    global_load_dwordx4 v[32:35], v253, s[4:5] offset:0 sc1
    global_load_dwordx4 v[36:39], v253, s[4:5] offset:1024 sc1
    global_load_dwordx4 v[40:43], v253, s[4:5] offset:2048 sc1
    global_load_dwordx4 v[44:47], v253, s[4:5] offset:3072 sc1
    s_lshl_b32 s52, s47, 12
    s_add_u32 s47, s47, 1
    s_cmp_ge_u32 s47, 14
    s_cselect_b32 s47, 0, s47
    v_add_u32 v253, s52, v211
    global_load_dwordx4 v[48:51], v253, s[4:5] offset:0 sc1
    global_load_dwordx4 v[52:55], v253, s[4:5] offset:1024 sc1
    global_load_dwordx4 v[56:59], v253, s[4:5] offset:2048 sc1
    global_load_dwordx4 v[60:63], v253, s[4:5] offset:3072 sc1
    v_mov_b32 v112, 0
    v_mov_b32 v113, 0
    v_mov_b32 v114, 0
    v_mov_b32 v115, 0
    v_mov_b32 v116, 0
    v_mov_b32 v117, 0
    v_mov_b32 v118, 0
    v_mov_b32 v119, 0
    v_mov_b32 v120, 0
    v_mov_b32 v121, 0
    v_mov_b32 v122, 0
    v_mov_b32 v123, 0
    v_mov_b32 v124, 0
    v_mov_b32 v125, 0
    v_mov_b32 v126, 0
    v_mov_b32 v127, 0
    s_waitcnt lgkmcnt(0)
    s_barrier
    s_mov_b32 s67, s46
    s_add_u32 s46, s46, 1
    s_cmp_ge_u32 s46, 14
    s_cselect_b32 s46, 0, s46
    s_lshl_b32 s52, s67, 17
    s_add_u32 s50, s45, 49152
    s_mov_b32 m0, s50
    s_add_u32 s51, s52, 0
    buffer_load_dwordx4 v212, s[8:11], s51 offen lds
    s_add_u32 s50, s45, 50176
    s_mov_b32 m0, s50
    s_add_u32 s51, s52, 8192
    buffer_load_dwordx4 v213, s[8:11], s51 offen lds
    s_add_u32 s50, s45, 51200
    s_mov_b32 m0, s50
    s_add_u32 s51, s52, 16384
    buffer_load_dwordx4 v212, s[8:11], s51 offen lds
    s_add_u32 s50, s45, 52224
    s_mov_b32 m0, s50
    s_add_u32 s51, s52, 24576
    buffer_load_dwordx4 v213, s[8:11], s51 offen lds
    ds_read_b64_tr_b16 v[80:81], v214 offset:0
    ds_read_b64_tr_b16 v[82:83], v214 offset:512
    ds_read_b64_tr_b16 v[84:85], v215 offset:0
    ds_read_b64_tr_b16 v[86:87], v215 offset:512
    ds_read_b64_tr_b16 v[88:89], v216 offset:0
    ds_read_b64_tr_b16 v[90:91], v216 offset:512
    ds_read_b64_tr_b16 v[92:93], v217 offset:0
    ds_read_b64_tr_b16 v[94:95], v217 offset:512
    s_waitcnt vmcnt(15)
    ds_read_b64_tr_b16 v[96:97], v214 offset:4096
    ds_read_b64_tr_b16 v[98:99], v214 offset:4608
    s_waitcnt lgkmcnt(8)
    v_mfma_f32_16x16x32_bf16 v[112:115], v[80:83], v[16:19], v[112:115]
    ds_read_b64_tr_b16 v[100:101], v215 offset:4096
    ds_read_b64_tr_b16 v[102:103], v215 offset:4608
    s_waitcnt lgkmcnt(8)
    v_mfma_f32_16x16x32_bf16 v[116:119], v[84:87], v[16:19], v[116:119]
    ds_read_b64_tr_b16 v[104:105], v216 offset:4096
    ds_read_b64_tr_b16 v[106:107], v216 offset:4608
    s_waitcnt lgkmcnt(8)
    v_mfma_f32_16x16x32_bf16 v[120:123], v[88:91], v[16:19], v[120:123]
    ds_read_b64_tr_b16 v[108:109], v217 offset:4096
    ds_read_b64_tr_b16 v[110:111], v217 offset:4608
    s_waitcnt lgkmcnt(8)
    v_mfma_f32_16x16x32_bf16 v[124:127], v[92:95], v[16:19], v[124:127]
    s_waitcnt vmcnt(14)
    ds_read_b64_tr_b16 v[80:81], v214 offset:8192
    ds_read_b64_tr_b16 v[82:83], v214 offset:8704
    s_waitcnt lgkmcnt(8)
    v_mfma_f32_16x16x32_bf16 v[112:115], v[96:99], v[20:23], v[112:115]
    ds_read_b64_tr_b16 v[84:85], v215 offset:8192
    ds_read_b64_tr_b16 v[86:87], v215 offset:8704
    s_waitcnt lgkmcnt(8)
    v_mfma_f32_16x16x32_bf16 v[116:119], v[100:103], v[20:23], v[116:119]
    ds_read_b64_tr_b16 v[88:89], v216 offset:8192
    ds_read_b64_tr_b16 v[90:91], v216 offset:8704
    s_waitcnt lgkmcnt(8)
    v_mfma_f32_16x16x32_bf16 v[120:123], v[104:107], v[20:23], v[120:123]
    ds_read_b64_tr_b16 v[92:93], v217 offset:8192
    ds_read_b64_tr_b16 v[94:95], v217 offset:8704
    s_waitcnt lgkmcnt(8)
    v_mfma_f32_16x16x32_bf16 v[124:127], v[108:111], v[20:23], v[124:127]
    s_waitcnt vmcnt(13)
    ds_read_b64_tr_b16 v[96:97], v214 offset:12288
    ds_read_b64_tr_b16 v[98:99], v214 offset:12800
    s_waitcnt lgkmcnt(8)
    v_mfma_f32_16x16x32_bf16 v[112:115], v[80:83], v[24:27], v[112:115]
    ds_read_b64_tr_b16 v[100:101], v215 offset:12288
    ds_read_b64_tr_b16 v[102:103], v215 offset:12800
    s_waitcnt lgkmcnt(8)
    v_mfma_f32_16x16x32_bf16 v[116:119], v[84:87], v[24:27], v[116:119]
    ds_read_b64_tr_b16 v[104:105], v216 offset:12288
    ds_read_b64_tr_b16 v[106:107], v216 offset:12800
    s_waitcnt lgkmcnt(8)
    v_mfma_f32_16x16x32_bf16 v[120:123], v[88:91], v[24:27], v[120:123]
    ds_read_b64_tr_b16 v[108:109], v217 offset:12288
    ds_read_b64_tr_b16 v[110:111], v217 offset:12800
    s_waitcnt lgkmcnt(8)
    v_mfma_f32_16x16x32_bf16 v[124:127], v[92:95], v[24:27], v[124:127]
    s_waitcnt lgkmcnt(0)
    s_barrier
    s_mov_b32 s64, s46
    s_add_u32 s46, s46, 1
    s_cmp_ge_u32 s46, 14
    s_cselect_b32 s46, 0, s46
    s_lshl_b32 s52, s64, 17
    s_add_u32 s50, s45, 0
    s_mov_b32 m0, s50
    s_add_u32 s51, s52, 0
    buffer_load_dwordx4 v212, s[8:11], s51 offen lds
    s_add_u32 s50, s45, 1024
    s_mov_b32 m0, s50
    s_add_u32 s51, s52, 8192
    buffer_load_dwordx4 v213, s[8:11], s51 offen lds
    s_add_u32 s50, s45, 2048
    s_mov_b32 m0, s50
    s_add_u32 s51, s52, 16384
    buffer_load_dwordx4 v212, s[8:11], s51 offen lds
    s_add_u32 s50, s45, 3072
    s_mov_b32 m0, s50
    s_add_u32 s51, s52, 24576
    buffer_load_dwordx4 v213, s[8:11], s51 offen lds
    s_waitcnt vmcnt(16)
    ds_read_b64_tr_b16 v[80:81], v214 offset:16384
    ds_read_b64_tr_b16 v[82:83], v214 offset:16896
    v_mfma_f32_16x16x32_bf16 v[112:115], v[96:99], v[28:31], v[112:115]
    ds_read_b64_tr_b16 v[84:85], v215 offset:16384
    ds_read_b64_tr_b16 v[86:87], v215 offset:16896
    v_mfma_f32_16x16x32_bf16 v[116:119], v[100:103], v[28:31], v[116:119]
    ds_read_b64_tr_b16 v[88:89], v216 offset:16384
    ds_read_b64_tr_b16 v[90:91], v216 offset:16896
    v_mfma_f32_16x16x32_bf16 v[120:123], v[104:107], v[28:31], v[120:123]
    ds_read_b64_tr_b16 v[92:93], v217 offset:16384
    ds_read_b64_tr_b16 v[94:95], v217 offset:16896
    v_mfma_f32_16x16x32_bf16 v[124:127], v[108:111], v[28:31], v[124:127]
    s_lshl_b32 s52, s47, 12
    s_add_u32 s47, s47, 1
    s_cmp_ge_u32 s47, 14
    s_cselect_b32 s47, 0, s47
    v_add_u32 v253, s52, v211
    global_load_dwordx4 v[64:67], v253, s[4:5] offset:0 sc1
    global_load_dwordx4 v[68:71], v253, s[4:5] offset:1024 sc1
    global_load_dwordx4 v[72:75], v253, s[4:5] offset:2048 sc1
    global_load_dwordx4 v[76:79], v253, s[4:5] offset:3072 sc1
    s_waitcnt vmcnt(19)
    ds_read_b64_tr_b16 v[96:97], v214 offset:20480
    ds_read_b64_tr_b16 v[98:99], v214 offset:20992
    s_waitcnt lgkmcnt(8)
    v_mfma_f32_16x16x32_bf16 v[112:115], v[80:83], v[32:35], v[112:115]
    ds_read_b64_tr_b16 v[100:101], v215 offset:20480
    ds_read_b64_tr_b16 v[102:103], v215 offset:20992
    s_waitcnt lgkmcnt(8)
    v_mfma_f32_16x16x32_bf16 v[116:119], v[84:87], v[32:35], v[116:119]
    ds_read_b64_tr_b16 v[104:105], v216 offset:20480
    ds_read_b64_tr_b16 v[106:107], v216 offset:20992
    s_waitcnt lgkmcnt(8)
    v_mfma_f32_16x16x32_bf16 v[120:123], v[88:91], v[32:35], v[120:123]
    ds_read_b64_tr_b16 v[108:109], v217 offset:20480
    ds_read_b64_tr_b16 v[110:111], v217 offset:20992
    s_waitcnt lgkmcnt(8)
    v_mfma_f32_16x16x32_bf16 v[124:127], v[92:95], v[32:35], v[124:127]
    s_waitcnt vmcnt(18)
    ds_read_b64_tr_b16 v[80:81], v214 offset:24576
    ds_read_b64_tr_b16 v[82:83], v214 offset:25088
    s_waitcnt lgkmcnt(8)
    v_mfma_f32_16x16x32_bf16 v[112:115], v[96:99], v[36:39], v[112:115]
    ds_read_b64_tr_b16 v[84:85], v215 offset:24576
    ds_read_b64_tr_b16 v[86:87], v215 offset:25088
    s_waitcnt lgkmcnt(8)
    v_mfma_f32_16x16x32_bf16 v[116:119], v[100:103], v[36:39], v[116:119]
    ds_read_b64_tr_b16 v[88:89], v216 offset:24576
    ds_read_b64_tr_b16 v[90:91], v216 offset:25088
    s_waitcnt lgkmcnt(8)
    v_mfma_f32_16x16x32_bf16 v[120:123], v[104:107], v[36:39], v[120:123]
    ds_read_b64_tr_b16 v[92:93], v217 offset:24576
    ds_read_b64_tr_b16 v[94:95], v217 offset:25088
    s_waitcnt lgkmcnt(8)
    v_mfma_f32_16x16x32_bf16 v[124:127], v[108:111], v[36:39], v[124:127]
    s_waitcnt vmcnt(17)
    ds_read_b64_tr_b16 v[96:97], v214 offset:28672
    ds_read_b64_tr_b16 v[98:99], v214 offset:29184
    s_waitcnt lgkmcnt(8)
    v_mfma_f32_16x16x32_bf16 v[112:115], v[80:83], v[40:43], v[112:115]
    ds_read_b64_tr_b16 v[100:101], v215 offset:28672
    ds_read_b64_tr_b16 v[102:103], v215 offset:29184
    s_waitcnt lgkmcnt(8)
    v_mfma_f32_16x16x32_bf16 v[116:119], v[84:87], v[40:43], v[116:119]
    ds_read_b64_tr_b16 v[104:105], v216 offset:28672
    ds_read_b64_tr_b16 v[106:107], v216 offset:29184
    s_waitcnt lgkmcnt(8)
    v_mfma_f32_16x16x32_bf16 v[120:123], v[88:91], v[40:43], v[120:123]
    ds_read_b64_tr_b16 v[108:109], v217 offset:28672
    ds_read_b64_tr_b16 v[110:111], v217 offset:29184
    s_waitcnt lgkmcnt(8)
    v_mfma_f32_16x16x32_bf16 v[124:127], v[92:95], v[40:43], v[124:127]
    s_waitcnt lgkmcnt(0)
    s_barrier
    s_mov_b32 s65, s46
    s_add_u32 s46, s46, 1
    s_cmp_ge_u32 s46, 14
    s_cselect_b32 s46, 0, s46
    s_lshl_b32 s52, s65, 17
    s_add_u32 s50, s45, 16384
    s_mov_b32 m0, s50
    s_add_u32 s51, s52, 0
    buffer_load_dwordx4 v212, s[8:11], s51 offen lds
    s_add_u32 s50, s45, 17408
    s_mov_b32 m0, s50
    s_add_u32 s51, s52, 8192
    buffer_load_dwordx4 v213, s[8:11], s51 offen lds
    s_add_u32 s50, s45, 18432
    s_mov_b32 m0, s50
    s_add_u32 s51, s52, 16384
    buffer_load_dwordx4 v212, s[8:11], s51 offen lds
    s_add_u32 s50, s45, 19456
    s_mov_b32 m0, s50
    s_add_u32 s51, s52, 24576
    buffer_load_dwordx4 v213, s[8:11], s51 offen lds
    s_waitcnt vmcnt(20)
    ds_read_b64_tr_b16 v[80:81], v214 offset:32768
    ds_read_b64_tr_b16 v[82:83], v214 offset:33280
    v_mfma_f32_16x16x32_bf16 v[112:115], v[96:99], v[44:47], v[112:115]
    ds_read_b64_tr_b16 v[84:85], v215 offset:32768
    ds_read_b64_tr_b16 v[86:87], v215 offset:33280
    v_mfma_f32_16x16x32_bf16 v[116:119], v[100:103], v[44:47], v[116:119]
    ds_read_b64_tr_b16 v[88:89], v216 offset:32768
    ds_read_b64_tr_b16 v[90:91], v216 offset:33280
    v_mfma_f32_16x16x32_bf16 v[120:123], v[104:107], v[44:47], v[120:123]
    ds_read_b64_tr_b16 v[92:93], v217 offset:32768
    ds_read_b64_tr_b16 v[94:95], v217 offset:33280
    v_mfma_f32_16x16x32_bf16 v[124:127], v[108:111], v[44:47], v[124:127]
    s_lshl_b32 s52, s47, 12
    s_add_u32 s47, s47, 1
    s_cmp_ge_u32 s47, 14
    s_cselect_b32 s47, 0, s47
    v_add_u32 v253, s52, v211
    global_load_dwordx4 v[16:19], v253, s[4:5] offset:0 sc1
    global_load_dwordx4 v[20:23], v253, s[4:5] offset:1024 sc1
    global_load_dwordx4 v[24:27], v253, s[4:5] offset:2048 sc1
    global_load_dwordx4 v[28:31], v253, s[4:5] offset:3072 sc1
    s_waitcnt vmcnt(23)
    ds_read_b64_tr_b16 v[96:97], v214 offset:36864
    ds_read_b64_tr_b16 v[98:99], v214 offset:37376
    s_waitcnt lgkmcnt(8)
    v_mfma_f32_16x16x32_bf16 v[112:115], v[80:83], v[48:51], v[112:115]
    ds_read_b64_tr_b16 v[100:101], v215 offset:36864
    ds_read_b64_tr_b16 v[102:103], v215 offset:37376
    s_waitcnt lgkmcnt(8)
    v_mfma_f32_16x16x32_bf16 v[116:119], v[84:87], v[48:51], v[116:119]
    ds_read_b64_tr_b16 v[104:105], v216 offset:36864
    ds_read_b64_tr_b16 v[106:107], v216 offset:37376
    s_waitcnt lgkmcnt(8)
    v_mfma_f32_16x16x32_bf16 v[120:123], v[88:91], v[48:51], v[120:123]
    ds_read_b64_tr_b16 v[108:109], v217 offset:36864
    ds_read_b64_tr_b16 v[110:111], v217 offset:37376
    s_waitcnt lgkmcnt(8)
    v_mfma_f32_16x16x32_bf16 v[124:127], v[92:95], v[48:51], v[124:127]
    s_waitcnt vmcnt(22)
    ds_read_b64_tr_b16 v[80:81], v214 offset:40960
    ds_read_b64_tr_b16 v[82:83], v214 offset:41472
    s_waitcnt lgkmcnt(8)
    v_mfma_f32_16x16x32_bf16 v[112:115], v[96:99], v[52:55], v[112:115]
    ds_read_b64_tr_b16 v[84:85], v215 offset:40960
    ds_read_b64_tr_b16 v[86:87], v215 offset:41472
    s_waitcnt lgkmcnt(8)
    v_mfma_f32_16x16x32_bf16 v[116:119], v[100:103], v[52:55], v[116:119]
    ds_read_b64_tr_b16 v[88:89], v216 offset:40960
    ds_read_b64_tr_b16 v[90:91], v216 offset:41472
    s_waitcnt lgkmcnt(8)
    v_mfma_f32_16x16x32_bf16 v[120:123], v[104:107], v[52:55], v[120:123]
    ds_read_b64_tr_b16 v[92:93], v217 offset:40960
    ds_read_b64_tr_b16 v[94:95], v217 offset:41472
    s_waitcnt lgkmcnt(8)
    v_mfma_f32_16x16x32_bf16 v[124:127], v[108:111], v[52:55], v[124:127]
    s_waitcnt vmcnt(21)
    ds_read_b64_tr_b16 v[96:97], v214 offset:45056
    ds_read_b64_tr_b16 v[98:99], v214 offset:45568
    s_waitcnt lgkmcnt(8)
    v_mfma_f32_16x16x32_bf16 v[112:115], v[80:83], v[56:59], v[112:115]
    ds_read_b64_tr_b16 v[100:101], v215 offset:45056
    ds_read_b64_tr_b16 v[102:103], v215 offset:45568
    s_waitcnt lgkmcnt(8)
    v_mfma_f32_16x16x32_bf16 v[116:119], v[84:87], v[56:59], v[116:119]
    ds_read_b64_tr_b16 v[104:105], v216 offset:45056
    ds_read_b64_tr_b16 v[106:107], v216 offset:45568
    s_waitcnt lgkmcnt(8)
    v_mfma_f32_16x16x32_bf16 v[120:123], v[88:91], v[56:59], v[120:123]
    ds_read_b64_tr_b16 v[108:109], v217 offset:45056
    ds_read_b64_tr_b16 v[110:111], v217 offset:45568
    s_waitcnt lgkmcnt(8)
    v_mfma_f32_16x16x32_bf16 v[124:127], v[92:95], v[56:59], v[124:127]
    s_waitcnt vmcnt(16)
    s_waitcnt lgkmcnt(0)
    s_barrier
    s_mov_b32 s66, s46
    s_add_u32 s46, s46, 1
    s_cmp_ge_u32 s46, 14
    s_cselect_b32 s46, 0, s46
    s_lshl_b32 s52, s66, 17
    s_add_u32 s50, s45, 32768
    s_mov_b32 m0, s50
    s_add_u32 s51, s52, 0
    buffer_load_dwordx4 v212, s[8:11], s51 offen lds
    s_add_u32 s50, s45, 33792
    s_mov_b32 m0, s50
    s_add_u32 s51, s52, 8192
    buffer_load_dwordx4 v213, s[8:11], s51 offen lds
    s_add_u32 s50, s45, 34816
    s_mov_b32 m0, s50
    s_add_u32 s51, s52, 16384
    buffer_load_dwordx4 v212, s[8:11], s51 offen lds
    s_add_u32 s50, s45, 35840
    s_mov_b32 m0, s50
    s_add_u32 s51, s52, 24576
    buffer_load_dwordx4 v213, s[8:11], s51 offen lds
    ds_read_b64_tr_b16 v[80:81], v214 offset:49152
    ds_read_b64_tr_b16 v[82:83], v214 offset:49664
    v_mfma_f32_16x16x32_bf16 v[112:115], v[96:99], v[60:63], v[112:115]
    ds_read_b64_tr_b16 v[84:85], v215 offset:49152
    ds_read_b64_tr_b16 v[86:87], v215 offset:49664
    v_mfma_f32_16x16x32_bf16 v[116:119], v[100:103], v[60:63], v[116:119]
    ds_read_b64_tr_b16 v[88:89], v216 offset:49152
    ds_read_b64_tr_b16 v[90:91], v216 offset:49664
    v_mfma_f32_16x16x32_bf16 v[120:123], v[104:107], v[60:63], v[120:123]
    ds_read_b64_tr_b16 v[92:93], v217 offset:49152
    ds_read_b64_tr_b16 v[94:95], v217 offset:49664
    v_mfma_f32_16x16x32_bf16 v[124:127], v[108:111], v[60:63], v[124:127]
    s_lshl_b32 s52, s47, 12
    s_add_u32 s47, s47, 1
    s_cmp_ge_u32 s47, 14
    s_cselect_b32 s47, 0, s47
    v_add_u32 v253, s52, v211
    global_load_dwordx4 v[32:35], v253, s[4:5] offset:0 sc1
    global_load_dwordx4 v[36:39], v253, s[4:5] offset:1024 sc1
    global_load_dwordx4 v[40:43], v253, s[4:5] offset:2048 sc1
    global_load_dwordx4 v[44:47], v253, s[4:5] offset:3072 sc1
    s_waitcnt vmcnt(19)
    ds_read_b64_tr_b16 v[96:97], v214 offset:53248
    ds_read_b64_tr_b16 v[98:99], v214 offset:53760
    s_waitcnt lgkmcnt(8)
    v_mfma_f32_16x16x32_bf16 v[112:115], v[80:83], v[64:67], v[112:115]
    ds_read_b64_tr_b16 v[100:101], v215 offset:53248
    ds_read_b64_tr_b16 v[102:103], v215 offset:53760
    s_waitcnt lgkmcnt(8)
    v_mfma_f32_16x16x32_bf16 v[116:119], v[84:87], v[64:67], v[116:119]
    ds_read_b64_tr_b16 v[104:105], v216 offset:53248
    ds_read_b64_tr_b16 v[106:107], v216 offset:53760
    s_waitcnt lgkmcnt(8)
    v_mfma_f32_16x16x32_bf16 v[120:123], v[88:91], v[64:67], v[120:123]
    ds_read_b64_tr_b16 v[108:109], v217 offset:53248
    ds_read_b64_tr_b16 v[110:111], v217 offset:53760
    s_waitcnt lgkmcnt(8)
    v_mfma_f32_16x16x32_bf16 v[124:127], v[92:95], v[64:67], v[124:127]
    s_waitcnt vmcnt(18)
    ds_read_b64_tr_b16 v[80:81], v214 offset:57344
    ds_read_b64_tr_b16 v[82:83], v214 offset:57856
    s_waitcnt lgkmcnt(8)
    v_mfma_f32_16x16x32_bf16 v[112:115], v[96:99], v[68:71], v[112:115]
    ds_read_b64_tr_b16 v[84:85], v215 offset:57344
    ds_read_b64_tr_b16 v[86:87], v215 offset:57856
    s_waitcnt lgkmcnt(8)
    v_mfma_f32_16x16x32_bf16 v[116:119], v[100:103], v[68:71], v[116:119]
    ds_read_b64_tr_b16 v[88:89], v216 offset:57344
    ds_read_b64_tr_b16 v[90:91], v216 offset:57856
    s_waitcnt lgkmcnt(8)
    v_mfma_f32_16x16x32_bf16 v[120:123], v[104:107], v[68:71], v[120:123]
    ds_read_b64_tr_b16 v[92:93], v217 offset:57344
    ds_read_b64_tr_b16 v[94:95], v217 offset:57856
    s_waitcnt lgkmcnt(8)
    v_mfma_f32_16x16x32_bf16 v[124:127], v[108:111], v[68:71], v[124:127]
    s_waitcnt vmcnt(17)
    ds_read_b64_tr_b16 v[96:97], v214 offset:61440
    ds_read_b64_tr_b16 v[98:99], v214 offset:61952
    s_waitcnt lgkmcnt(8)
    v_mfma_f32_16x16x32_bf16 v[112:115], v[80:83], v[72:75], v[112:115]
    ds_read_b64_tr_b16 v[100:101], v215 offset:61440
    ds_read_b64_tr_b16 v[102:103], v215 offset:61952
    s_waitcnt lgkmcnt(8)
    v_mfma_f32_16x16x32_bf16 v[116:119], v[84:87], v[72:75], v[116:119]
    ds_read_b64_tr_b16 v[104:105], v216 offset:61440
    ds_read_b64_tr_b16 v[106:107], v216 offset:61952
    s_waitcnt lgkmcnt(8)
    v_mfma_f32_16x16x32_bf16 v[120:123], v[88:91], v[72:75], v[120:123]
    ds_read_b64_tr_b16 v[108:109], v217 offset:61440
    ds_read_b64_tr_b16 v[110:111], v217 offset:61952
    s_waitcnt lgkmcnt(8)
    v_mfma_f32_16x16x32_bf16 v[124:127], v[92:95], v[72:75], v[124:127]
    s_waitcnt lgkmcnt(0)
    s_barrier
    s_mov_b32 s67, s46
    s_add_u32 s46, s46, 1
    s_cmp_ge_u32 s46, 14
    s_cselect_b32 s46, 0, s46
    s_lshl_b32 s52, s67, 17
    s_add_u32 s50, s45, 49152
    s_mov_b32 m0, s50
    s_add_u32 s51, s52, 0
    buffer_load_dwordx4 v212, s[8:11], s51 offen lds
    s_add_u32 s50, s45, 50176
    s_mov_b32 m0, s50
    s_add_u32 s51, s52, 8192
    buffer_load_dwordx4 v213, s[8:11], s51 offen lds
    s_add_u32 s50, s45, 51200
    s_mov_b32 m0, s50
    s_add_u32 s51, s52, 16384
    buffer_load_dwordx4 v212, s[8:11], s51 offen lds
    s_add_u32 s50, s45, 52224
    s_mov_b32 m0, s50
    s_add_u32 s51, s52, 24576
    buffer_load_dwordx4 v213, s[8:11], s51 offen lds
    s_waitcnt vmcnt(20)
    ds_read_b64_tr_b16 v[80:81], v214 offset:0
    ds_read_b64_tr_b16 v[82:83], v214 offset:512
    v_mfma_f32_16x16x32_bf16 v[112:115], v[96:99], v[76:79], v[112:115]
    ds_read_b64_tr_b16 v[84:85], v215 offset:0
    ds_read_b64_tr_b16 v[86:87], v215 offset:512
    v_mfma_f32_16x16x32_bf16 v[116:119], v[100:103], v[76:79], v[116:119]
    ds_read_b64_tr_b16 v[88:89], v216 offset:0
    ds_read_b64_tr_b16 v[90:91], v216 offset:512
    v_mfma_f32_16x16x32_bf16 v[120:123], v[104:107], v[76:79], v[120:123]
    ds_read_b64_tr_b16 v[92:93], v217 offset:0
    ds_read_b64_tr_b16 v[94:95], v217 offset:512
    v_mfma_f32_16x16x32_bf16 v[124:127], v[108:111], v[76:79], v[124:127]
    s_lshl_b32 s52, s47, 12
    s_add_u32 s47, s47, 1
    s_cmp_ge_u32 s47, 14
    s_cselect_b32 s47, 0, s47
    v_add_u32 v253, s52, v211
    global_load_dwordx4 v[48:51], v253, s[4:5] offset:0 sc1
    global_load_dwordx4 v[52:55], v253, s[4:5] offset:1024 sc1
    global_load_dwordx4 v[56:59], v253, s[4:5] offset:2048 sc1
    global_load_dwordx4 v[60:63], v253, s[4:5] offset:3072 sc1
    s_waitcnt vmcnt(19)
    ds_read_b64_tr_b16 v[96:97], v214 offset:4096
    ds_read_b64_tr_b16 v[98:99], v214 offset:4608
    s_waitcnt lgkmcnt(8)
    v_mfma_f32_16x16x32_bf16 v[112:115], v[80:83], v[16:19], v[112:115]
    ds_read_b64_tr_b16 v[100:101], v215 offset:4096
    ds_read_b64_tr_b16 v[102:103], v215 offset:4608
    s_waitcnt lgkmcnt(8)
    v_mfma_f32_16x16x32_bf16 v[116:119], v[84:87], v[16:19], v[116:119]
    ds_read_b64_tr_b16 v[104:105], v216 offset:4096
    ds_read_b64_tr_b16 v[106:107], v216 offset:4608
    s_waitcnt lgkmcnt(8)
    v_mfma_f32_16x16x32_bf16 v[120:123], v[88:91], v[16:19], v[120:123]
    ds_read_b64_tr_b16 v[108:109], v217 offset:4096
    ds_read_b64_tr_b16 v[110:111], v217 offset:4608
    s_waitcnt lgkmcnt(8)
    v_mfma_f32_16x16x32_bf16 v[124:127], v[92:95], v[16:19], v[124:127]
    s_waitcnt vmcnt(18)
    ds_read_b64_tr_b16 v[80:81], v214 offset:8192
    ds_read_b64_tr_b16 v[82:83], v214 offset:8704
    s_waitcnt lgkmcnt(8)
    v_mfma_f32_16x16x32_bf16 v[112:115], v[96:99], v[20:23], v[112:115]
    ds_read_b64_tr_b16 v[84:85], v215 offset:8192
    ds_read_b64_tr_b16 v[86:87], v215 offset:8704
    s_waitcnt lgkmcnt(8)
    v_mfma_f32_16x16x32_bf16 v[116:119], v[100:103], v[20:23], v[116:119]
    ds_read_b64_tr_b16 v[88:89], v216 offset:8192
    ds_read_b64_tr_b16 v[90:91], v216 offset:8704
    s_waitcnt lgkmcnt(8)
    v_mfma_f32_16x16x32_bf16 v[120:123], v[104:107], v[20:23], v[120:123]
    ds_read_b64_tr_b16 v[92:93], v217 offset:8192
    ds_read_b64_tr_b16 v[94:95], v217 offset:8704
    s_waitcnt lgkmcnt(8)
    v_mfma_f32_16x16x32_bf16 v[124:127], v[108:111], v[20:23], v[124:127]
    s_waitcnt vmcnt(17)
    ds_read_b64_tr_b16 v[96:97], v214 offset:12288
    ds_read_b64_tr_b16 v[98:99], v214 offset:12800
    s_waitcnt lgkmcnt(8)
    v_mfma_f32_16x16x32_bf16 v[112:115], v[80:83], v[24:27], v[112:115]
    ds_read_b64_tr_b16 v[100:101], v215 offset:12288
    ds_read_b64_tr_b16 v[102:103], v215 offset:12800
    s_waitcnt lgkmcnt(8)
    v_mfma_f32_16x16x32_bf16 v[116:119], v[84:87], v[24:27], v[116:119]
    ds_read_b64_tr_b16 v[104:105], v216 offset:12288
    ds_read_b64_tr_b16 v[106:107], v216 offset:12800
    s_waitcnt lgkmcnt(8)
    v_mfma_f32_16x16x32_bf16 v[120:123], v[88:91], v[24:27], v[120:123]
    ds_read_b64_tr_b16 v[108:109], v217 offset:12288
    ds_read_b64_tr_b16 v[110:111], v217 offset:12800
    s_waitcnt lgkmcnt(8)
    v_mfma_f32_16x16x32_bf16 v[124:127], v[92:95], v[24:27], v[124:127]
    s_waitcnt lgkmcnt(0)
    s_barrier
    s_mov_b32 s64, s46
    s_add_u32 s46, s46, 1
    s_cmp_ge_u32 s46, 14
    s_cselect_b32 s46, 0, s46
    s_lshl_b32 s52, s64, 17
    s_add_u32 s50, s45, 0
    s_mov_b32 m0, s50
    s_add_u32 s51, s52, 0
    buffer_load_dwordx4 v212, s[8:11], s51 offen lds
    s_add_u32 s50, s45, 1024
    s_mov_b32 m0, s50
    s_add_u32 s51, s52, 8192
    buffer_load_dwordx4 v213, s[8:11], s51 offen lds
    s_add_u32 s50, s45, 2048
    s_mov_b32 m0, s50
    s_add_u32 s51, s52, 16384
    buffer_load_dwordx4 v212, s[8:11], s51 offen lds
    s_add_u32 s50, s45, 3072
    s_mov_b32 m0, s50
    s_add_u32 s51, s52, 24576
    buffer_load_dwordx4 v213, s[8:11], s51 offen lds
    s_waitcnt vmcnt(20)
    ds_read_b64_tr_b16 v[80:81], v214 offset:16384
    ds_read_b64_tr_b16 v[82:83], v214 offset:16896
    v_mfma_f32_16x16x32_bf16 v[112:115], v[96:99], v[28:31], v[112:115]
    ds_read_b64_tr_b16 v[84:85], v215 offset:16384
    ds_read_b64_tr_b16 v[86:87], v215 offset:16896
    v_mfma_f32_16x16x32_bf16 v[116:119], v[100:103], v[28:31], v[116:119]
    ds_read_b64_tr_b16 v[88:89], v216 offset:16384
    ds_read_b64_tr_b16 v[90:91], v216 offset:16896
    v_mfma_f32_16x16x32_bf16 v[120:123], v[104:107], v[28:31], v[120:123]
    ds_read_b64_tr_b16 v[92:93], v217 offset:16384
    ds_read_b64_tr_b16 v[94:95], v217 offset:16896
    v_mfma_f32_16x16x32_bf16 v[124:127], v[108:111], v[28:31], v[124:127]
    s_lshl_b32 s52, s47, 12
    s_add_u32 s47, s47, 1
    s_cmp_ge_u32 s47, 14
    s_cselect_b32 s47, 0, s47
    v_add_u32 v253, s52, v211
    global_load_dwordx4 v[64:67], v253, s[4:5] offset:0 sc1
    global_load_dwordx4 v[68:71], v253, s[4:5] offset:1024 sc1
    global_load_dwordx4 v[72:75], v253, s[4:5] offset:2048 sc1
    global_load_dwordx4 v[76:79], v253, s[4:5] offset:3072 sc1
    s_waitcnt vmcnt(19)
    ds_read_b64_tr_b16 v[96:97], v214 offset:20480
    ds_read_b64_tr_b16 v[98:99], v214 offset:20992
    s_waitcnt lgkmcnt(8)
    v_mfma_f32_16x16x32_bf16 v[112:115], v[80:83], v[32:35], v[112:115]
    ds_read_b64_tr_b16 v[100:101], v215 offset:20480
    ds_read_b64_tr_b16 v[102:103], v215 offset:20992
    s_waitcnt lgkmcnt(8)
    v_mfma_f32_16x16x32_bf16 v[116:119], v[84:87], v[32:35], v[116:119]
    ds_read_b64_tr_b16 v[104:105], v216 offset:20480
    ds_read_b64_tr_b16 v[106:107], v216 offset:20992
    s_waitcnt lgkmcnt(8)
    v_mfma_f32_16x16x32_bf16 v[120:123], v[88:91], v[32:35], v[120:123]
    ds_read_b64_tr_b16 v[108:109], v217 offset:20480
    ds_read_b64_tr_b16 v[110:111], v217 offset:20992
    s_waitcnt lgkmcnt(8)
    v_mfma_f32_16x16x32_bf16 v[124:127], v[92:95], v[32:35], v[124:127]
    s_waitcnt vmcnt(18)
    ds_read_b64_tr_b16 v[80:81], v214 offset:24576
    ds_read_b64_tr_b16 v[82:83], v214 offset:25088
    s_waitcnt lgkmcnt(8)
    v_mfma_f32_16x16x32_bf16 v[112:115], v[96:99], v[36:39], v[112:115]
    ds_read_b64_tr_b16 v[84:85], v215 offset:24576
    ds_read_b64_tr_b16 v[86:87], v215 offset:25088
    s_waitcnt lgkmcnt(8)
    v_mfma_f32_16x16x32_bf16 v[116:119], v[100:103], v[36:39], v[116:119]
    ds_read_b64_tr_b16 v[88:89], v216 offset:24576
    ds_read_b64_tr_b16 v[90:91], v216 offset:25088
    s_waitcnt lgkmcnt(8)
    v_mfma_f32_16x16x32_bf16 v[120:123], v[104:107], v[36:39], v[120:123]
    ds_read_b64_tr_b16 v[92:93], v217 offset:24576
    ds_read_b64_tr_b16 v[94:95], v217 offset:25088
    s_waitcnt lgkmcnt(8)
    v_mfma_f32_16x16x32_bf16 v[124:127], v[108:111], v[36:39], v[124:127]
    s_waitcnt vmcnt(17)
    ds_read_b64_tr_b16 v[96:97], v214 offset:28672
    ds_read_b64_tr_b16 v[98:99], v214 offset:29184
    s_waitcnt lgkmcnt(8)
    v_mfma_f32_16x16x32_bf16 v[112:115], v[80:83], v[40:43], v[112:115]
    ds_read_b64_tr_b16 v[100:101], v215 offset:28672
    ds_read_b64_tr_b16 v[102:103], v215 offset:29184
    s_waitcnt lgkmcnt(8)
    v_mfma_f32_16x16x32_bf16 v[116:119], v[84:87], v[40:43], v[116:119]
    ds_read_b64_tr_b16 v[104:105], v216 offset:28672
    ds_read_b64_tr_b16 v[106:107], v216 offset:29184
    s_waitcnt lgkmcnt(8)
    v_mfma_f32_16x16x32_bf16 v[120:123], v[88:91], v[40:43], v[120:123]
    ds_read_b64_tr_b16 v[108:109], v217 offset:28672
    ds_read_b64_tr_b16 v[110:111], v217 offset:29184
    s_waitcnt lgkmcnt(8)
    v_mfma_f32_16x16x32_bf16 v[124:127], v[92:95], v[40:43], v[124:127]
    s_waitcnt lgkmcnt(0)
    s_barrier
    s_mov_b32 s65, s46
    s_add_u32 s46, s46, 1
    s_cmp_ge_u32 s46, 14
    s_cselect_b32 s46, 0, s46
    s_lshl_b32 s52, s65, 17
    s_add_u32 s50, s45, 16384
    s_mov_b32 m0, s50
    s_add_u32 s51, s52, 0
    buffer_load_dwordx4 v212, s[8:11], s51 offen lds
    s_add_u32 s50, s45, 17408
    s_mov_b32 m0, s50
    s_add_u32 s51, s52, 8192
    buffer_load_dwordx4 v213, s[8:11], s51 offen lds
    s_add_u32 s50, s45, 18432
    s_mov_b32 m0, s50
    s_add_u32 s51, s52, 16384
    buffer_load_dwordx4 v212, s[8:11], s51 offen lds
    s_add_u32 s50, s45, 19456
    s_mov_b32 m0, s50
    s_add_u32 s51, s52, 24576
    buffer_load_dwordx4 v213, s[8:11], s51 offen lds
    s_waitcnt vmcnt(20)
    ds_read_b64_tr_b16 v[80:81], v214 offset:32768
    ds_read_b64_tr_b16 v[82:83], v214 offset:33280
    v_mfma_f32_16x16x32_bf16 v[112:115], v[96:99], v[44:47], v[112:115]
    ds_read_b64_tr_b16 v[84:85], v215 offset:32768
    ds_read_b64_tr_b16 v[86:87], v215 offset:33280
    v_mfma_f32_16x16x32_bf16 v[116:119], v[100:103], v[44:47], v[116:119]
    ds_read_b64_tr_b16 v[88:89], v216 offset:32768
    ds_read_b64_tr_b16 v[90:91], v216 offset:33280
    v_mfma_f32_16x16x32_bf16 v[120:123], v[104:107], v[44:47], v[120:123]
    ds_read_b64_tr_b16 v[92:93], v217 offset:32768
    ds_read_b64_tr_b16 v[94:95], v217 offset:33280
    v_mfma_f32_16x16x32_bf16 v[124:127], v[108:111], v[44:47], v[124:127]
    s_lshl_b32 s52, s47, 12
    s_add_u32 s47, s47, 1
    s_cmp_ge_u32 s47, 14
    s_cselect_b32 s47, 0, s47
    v_add_u32 v253, s52, v211
    global_load_dwordx4 v[16:19], v253, s[4:5] offset:0 sc1
    global_load_dwordx4 v[20:23], v253, s[4:5] offset:1024 sc1
    global_load_dwordx4 v[24:27], v253, s[4:5] offset:2048 sc1
    global_load_dwordx4 v[28:31], v253, s[4:5] offset:3072 sc1
    s_waitcnt vmcnt(19)
    ds_read_b64_tr_b16 v[96:97], v214 offset:36864
    ds_read_b64_tr_b16 v[98:99], v214 offset:37376
    s_waitcnt lgkmcnt(8)
    v_mfma_f32_16x16x32_bf16 v[112:115], v[80:83], v[48:51], v[112:115]
    ds_read_b64_tr_b16 v[100:101], v215 offset:36864
    ds_read_b64_tr_b16 v[102:103], v215 offset:37376
    s_waitcnt lgkmcnt(8)
    v_mfma_f32_16x16x32_bf16 v[116:119], v[84:87], v[48:51], v[116:119]
    ds_read_b64_tr_b16 v[104:105], v216 offset:36864
    ds_read_b64_tr_b16 v[106:107], v216 offset:37376
    s_waitcnt lgkmcnt(8)
    v_mfma_f32_16x16x32_bf16 v[120:123], v[88:91], v[48:51], v[120:123]
    ds_read_b64_tr_b16 v[108:109], v217 offset:36864
    ds_read_b64_tr_b16 v[110:111], v217 offset:37376
    s_waitcnt lgkmcnt(8)
    v_mfma_f32_16x16x32_bf16 v[124:127], v[92:95], v[48:51], v[124:127]
    s_waitcnt vmcnt(18)
    ds_read_b64_tr_b16 v[80:81], v214 offset:40960
    ds_read_b64_tr_b16 v[82:83], v214 offset:41472
    s_waitcnt lgkmcnt(8)
    v_mfma_f32_16x16x32_bf16 v[112:115], v[96:99], v[52:55], v[112:115]
    ds_read_b64_tr_b16 v[84:85], v215 offset:40960
    ds_read_b64_tr_b16 v[86:87], v215 offset:41472
    s_waitcnt lgkmcnt(8)
    v_mfma_f32_16x16x32_bf16 v[116:119], v[100:103], v[52:55], v[116:119]
    ds_read_b64_tr_b16 v[88:89], v216 offset:40960
    ds_read_b64_tr_b16 v[90:91], v216 offset:41472
    s_waitcnt lgkmcnt(8)
    v_mfma_f32_16x16x32_bf16 v[120:123], v[104:107], v[52:55], v[120:123]
    ds_read_b64_tr_b16 v[92:93], v217 offset:40960
    ds_read_b64_tr_b16 v[94:95], v217 offset:41472
    s_waitcnt lgkmcnt(8)
    v_mfma_f32_16x16x32_bf16 v[124:127], v[108:111], v[52:55], v[124:127]
    s_waitcnt vmcnt(17)
    ds_read_b64_tr_b16 v[96:97], v214 offset:45056
    ds_read_b64_tr_b16 v[98:99], v214 offset:45568
    s_waitcnt lgkmcnt(8)
    v_mfma_f32_16x16x32_bf16 v[112:115], v[80:83], v[56:59], v[112:115]
    ds_read_b64_tr_b16 v[100:101], v215 offset:45056
    ds_read_b64_tr_b16 v[102:103], v215 offset:45568
    s_waitcnt lgkmcnt(8)
    v_mfma_f32_16x16x32_bf16 v[116:119], v[84:87], v[56:59], v[116:119]
    ds_read_b64_tr_b16 v[104:105], v216 offset:45056
    ds_read_b64_tr_b16 v[106:107], v216 offset:45568
    s_waitcnt lgkmcnt(8)
    v_mfma_f32_16x16x32_bf16 v[120:123], v[88:91], v[56:59], v[120:123]
    ds_read_b64_tr_b16 v[108:109], v217 offset:45056
    ds_read_b64_tr_b16 v[110:111], v217 offset:45568
    s_waitcnt lgkmcnt(8)
    v_mfma_f32_16x16x32_bf16 v[124:127], v[92:95], v[56:59], v[124:127]
    s_waitcnt lgkmcnt(0)
    s_barrier
    s_mov_b32 s66, s46
    s_add_u32 s46, s46, 1
    s_cmp_ge_u32 s46, 14
    s_cselect_b32 s46, 0, s46
    s_lshl_b32 s52, s66, 17
    s_add_u32 s50, s45, 32768
    s_mov_b32 m0, s50
    s_add_u32 s51, s52, 0
    buffer_load_dwordx4 v212, s[8:11], s51 offen lds
    s_add_u32 s50, s45, 33792
    s_mov_b32 m0, s50
    s_add_u32 s51, s52, 8192
    buffer_load_dwordx4 v213, s[8:11], s51 offen lds
    s_add_u32 s50, s45, 34816
    s_mov_b32 m0, s50
    s_add_u32 s51, s52, 16384
    buffer_load_dwordx4 v212, s[8:11], s51 offen lds
    s_add_u32 s50, s45, 35840
    s_mov_b32 m0, s50
    s_add_u32 s51, s52, 24576
    buffer_load_dwordx4 v213, s[8:11], s51 offen lds
    s_waitcnt vmcnt(20)
    ds_read_b64_tr_b16 v[80:81], v214 offset:49152
    ds_read_b64_tr_b16 v[82:83], v214 offset:49664
    v_mfma_f32_16x16x32_bf16 v[112:115], v[96:99], v[60:63], v[112:115]
    ds_read_b64_tr_b16 v[84:85], v215 offset:49152
    ds_read_b64_tr_b16 v[86:87], v215 offset:49664
    v_mfma_f32_16x16x32_bf16 v[116:119], v[100:103], v[60:63], v[116:119]
    ds_read_b64_tr_b16 v[88:89], v216 offset:49152
    ds_read_b64_tr_b16 v[90:91], v216 offset:49664
    v_mfma_f32_16x16x32_bf16 v[120:123], v[104:107], v[60:63], v[120:123]
    ds_read_b64_tr_b16 v[92:93], v217 offset:49152
    ds_read_b64_tr_b16 v[94:95], v217 offset:49664
    v_mfma_f32_16x16x32_bf16 v[124:127], v[108:111], v[60:63], v[124:127]
    s_lshl_b32 s52, s47, 12
    s_add_u32 s47, s47, 1
    s_cmp_ge_u32 s47, 14
    s_cselect_b32 s47, 0, s47
    v_add_u32 v253, s52, v211
    global_load_dwordx4 v[32:35], v253, s[4:5] offset:0 sc1
    global_load_dwordx4 v[36:39], v253, s[4:5] offset:1024 sc1
    global_load_dwordx4 v[40:43], v253, s[4:5] offset:2048 sc1
    global_load_dwordx4 v[44:47], v253, s[4:5] offset:3072 sc1
    s_waitcnt vmcnt(19)
    ds_read_b64_tr_b16 v[96:97], v214 offset:53248
    ds_read_b64_tr_b16 v[98:99], v214 offset:53760
    s_waitcnt lgkmcnt(8)
    v_mfma_f32_16x16x32_bf16 v[112:115], v[80:83], v[64:67], v[112:115]
    ds_read_b64_tr_b16 v[100:101], v215 offset:53248
    ds_read_b64_tr_b16 v[102:103], v215 offset:53760
    s_waitcnt lgkmcnt(8)
    v_mfma_f32_16x16x32_bf16 v[116:119], v[84:87], v[64:67], v[116:119]
    ds_read_b64_tr_b16 v[104:105], v216 offset:53248
    ds_read_b64_tr_b16 v[106:107], v216 offset:53760
    s_waitcnt lgkmcnt(8)
    v_mfma_f32_16x16x32_bf16 v[120:123], v[88:91], v[64:67], v[120:123]
    ds_read_b64_tr_b16 v[108:109], v217 offset:53248
    ds_read_b64_tr_b16 v[110:111], v217 offset:53760
    s_waitcnt lgkmcnt(8)
    v_mfma_f32_16x16x32_bf16 v[124:127], v[92:95], v[64:67], v[124:127]
    s_waitcnt vmcnt(18)
    ds_read_b64_tr_b16 v[80:81], v214 offset:57344
    ds_read_b64_tr_b16 v[82:83], v214 offset:57856
    s_waitcnt lgkmcnt(8)
    v_mfma_f32_16x16x32_bf16 v[112:115], v[96:99], v[68:71], v[112:115]
    ds_read_b64_tr_b16 v[84:85], v215 offset:57344
    ds_read_b64_tr_b16 v[86:87], v215 offset:57856
    s_waitcnt lgkmcnt(8)
    v_mfma_f32_16x16x32_bf16 v[116:119], v[100:103], v[68:71], v[116:119]
    ds_read_b64_tr_b16 v[88:89], v216 offset:57344
    ds_read_b64_tr_b16 v[90:91], v216 offset:57856
    s_waitcnt lgkmcnt(8)
    v_mfma_f32_16x16x32_bf16 v[120:123], v[104:107], v[68:71], v[120:123]
    ds_read_b64_tr_b16 v[92:93], v217 offset:57344
    ds_read_b64_tr_b16 v[94:95], v217 offset:57856
    s_waitcnt lgkmcnt(8)
    v_mfma_f32_16x16x32_bf16 v[124:127], v[108:111], v[68:71], v[124:127]
    s_waitcnt vmcnt(17)
    ds_read_b64_tr_b16 v[96:97], v214 offset:61440
    ds_read_b64_tr_b16 v[98:99], v214 offset:61952
    s_waitcnt lgkmcnt(8)
    v_mfma_f32_16x16x32_bf16 v[112:115], v[80:83], v[72:75], v[112:115]
    ds_read_b64_tr_b16 v[100:101], v215 offset:61440
    ds_read_b64_tr_b16 v[102:103], v215 offset:61952
    s_waitcnt lgkmcnt(8)
    v_mfma_f32_16x16x32_bf16 v[116:119], v[84:87], v[72:75], v[116:119]
    ds_read_b64_tr_b16 v[104:105], v216 offset:61440
    ds_read_b64_tr_b16 v[106:107], v216 offset:61952
    s_waitcnt lgkmcnt(8)
    v_mfma_f32_16x16x32_bf16 v[120:123], v[88:91], v[72:75], v[120:123]
    ds_read_b64_tr_b16 v[108:109], v217 offset:61440
    ds_read_b64_tr_b16 v[110:111], v217 offset:61952
    s_waitcnt lgkmcnt(8)
    v_mfma_f32_16x16x32_bf16 v[124:127], v[92:95], v[72:75], v[124:127]
    s_waitcnt lgkmcnt(0)
    s_barrier
    s_mov_b32 s67, s46
    s_add_u32 s46, s46, 1
    s_cmp_ge_u32 s46, 14
    s_cselect_b32 s46, 0, s46
    s_lshl_b32 s52, s67, 17
    s_add_u32 s50, s45, 49152
    s_mov_b32 m0, s50
    s_add_u32 s51, s52, 0
    buffer_load_dwordx4 v212, s[8:11], s51 offen lds
    s_add_u32 s50, s45, 50176
    s_mov_b32 m0, s50
    s_add_u32 s51, s52, 8192
    buffer_load_dwordx4 v213, s[8:11], s51 offen lds
    s_add_u32 s50, s45, 51200
    s_mov_b32 m0, s50
    s_add_u32 s51, s52, 16384
    buffer_load_dwordx4 v212, s[8:11], s51 offen lds
    s_add_u32 s50, s45, 52224
    s_mov_b32 m0, s50
    s_add_u32 s51, s52, 24576
    buffer_load_dwordx4 v213, s[8:11], s51 offen lds
    s_waitcnt vmcnt(20)
    ds_read_b64_tr_b16 v[80:81], v214 offset:0
    ds_read_b64_tr_b16 v[82:83], v214 offset:512
    v_mfma_f32_16x16x32_bf16 v[112:115], v[96:99], v[76:79], v[112:115]
    ds_read_b64_tr_b16 v[84:85], v215 offset:0
    ds_read_b64_tr_b16 v[86:87], v215 offset:512
    v_mfma_f32_16x16x32_bf16 v[116:119], v[100:103], v[76:79], v[116:119]
    ds_read_b64_tr_b16 v[88:89], v216 offset:0
    ds_read_b64_tr_b16 v[90:91], v216 offset:512
    v_mfma_f32_16x16x32_bf16 v[120:123], v[104:107], v[76:79], v[120:123]
    ds_read_b64_tr_b16 v[92:93], v217 offset:0
    ds_read_b64_tr_b16 v[94:95], v217 offset:512
    v_mfma_f32_16x16x32_bf16 v[124:127], v[108:111], v[76:79], v[124:127]
    s_lshl_b32 s52, s47, 12
    s_add_u32 s47, s47, 1
    s_cmp_ge_u32 s47, 14
    s_cselect_b32 s47, 0, s47
    v_add_u32 v253, s52, v211
    global_load_dwordx4 v[48:51], v253, s[4:5] offset:0 sc1
    global_load_dwordx4 v[52:55], v253, s[4:5] offset:1024 sc1
    global_load_dwordx4 v[56:59], v253, s[4:5] offset:2048 sc1
    global_load_dwordx4 v[60:63], v253, s[4:5] offset:3072 sc1
    s_waitcnt vmcnt(19)
    ds_read_b64_tr_b16 v[96:97], v214 offset:4096
    ds_read_b64_tr_b16 v[98:99], v214 offset:4608
    s_waitcnt lgkmcnt(8)
    v_mfma_f32_16x16x32_bf16 v[112:115], v[80:83], v[16:19], v[112:115]
    ds_read_b64_tr_b16 v[100:101], v215 offset:4096
    ds_read_b64_tr_b16 v[102:103], v215 offset:4608
    s_waitcnt lgkmcnt(8)
    v_mfma_f32_16x16x32_bf16 v[116:119], v[84:87], v[16:19], v[116:119]
    ds_read_b64_tr_b16 v[104:105], v216 offset:4096
    ds_read_b64_tr_b16 v[106:107], v216 offset:4608
    s_waitcnt lgkmcnt(8)
    v_mfma_f32_16x16x32_bf16 v[120:123], v[88:91], v[16:19], v[120:123]
    ds_read_b64_tr_b16 v[108:109], v217 offset:4096
    ds_read_b64_tr_b16 v[110:111], v217 offset:4608
    s_waitcnt lgkmcnt(8)
    v_mfma_f32_16x16x32_bf16 v[124:127], v[92:95], v[16:19], v[124:127]
    s_waitcnt vmcnt(18)
    ds_read_b64_tr_b16 v[80:81], v214 offset:8192
    ds_read_b64_tr_b16 v[82:83], v214 offset:8704
    s_waitcnt lgkmcnt(8)
    v_mfma_f32_16x16x32_bf16 v[112:115], v[96:99], v[20:23], v[112:115]
    ds_read_b64_tr_b16 v[84:85], v215 offset:8192
    ds_read_b64_tr_b16 v[86:87], v215 offset:8704
    s_waitcnt lgkmcnt(8)
    v_mfma_f32_16x16x32_bf16 v[116:119], v[100:103], v[20:23], v[116:119]
    ds_read_b64_tr_b16 v[88:89], v216 offset:8192
    ds_read_b64_tr_b16 v[90:91], v216 offset:8704
    s_waitcnt lgkmcnt(8)
    v_mfma_f32_16x16x32_bf16 v[120:123], v[104:107], v[20:23], v[120:123]
    ds_read_b64_tr_b16 v[92:93], v217 offset:8192
    ds_read_b64_tr_b16 v[94:95], v217 offset:8704
    s_waitcnt lgkmcnt(8)
    v_mfma_f32_16x16x32_bf16 v[124:127], v[108:111], v[20:23], v[124:127]
    s_waitcnt vmcnt(17)
    ds_read_b64_tr_b16 v[96:97], v214 offset:12288
    ds_read_b64_tr_b16 v[98:99], v214 offset:12800
    s_waitcnt lgkmcnt(8)
    v_mfma_f32_16x16x32_bf16 v[112:115], v[80:83], v[24:27], v[112:115]
    ds_read_b64_tr_b16 v[100:101], v215 offset:12288
    ds_read_b64_tr_b16 v[102:103], v215 offset:12800
    s_waitcnt lgkmcnt(8)
    v_mfma_f32_16x16x32_bf16 v[116:119], v[84:87], v[24:27], v[116:119]
    ds_read_b64_tr_b16 v[104:105], v216 offset:12288
    ds_read_b64_tr_b16 v[106:107], v216 offset:12800
    s_waitcnt lgkmcnt(8)
    v_mfma_f32_16x16x32_bf16 v[120:123], v[88:91], v[24:27], v[120:123]
    ds_read_b64_tr_b16 v[108:109], v217 offset:12288
    ds_read_b64_tr_b16 v[110:111], v217 offset:12800
    s_waitcnt lgkmcnt(8)
    v_mfma_f32_16x16x32_bf16 v[124:127], v[92:95], v[24:27], v[124:127]
    s_waitcnt lgkmcnt(0)
    s_barrier
    s_mov_b32 s64, s46
    s_add_u32 s46, s46, 1
    s_cmp_ge_u32 s46, 14
    s_cselect_b32 s46, 0, s46
    s_lshl_b32 s52, s64, 17
    s_add_u32 s50, s45, 0
    s_mov_b32 m0, s50
    s_add_u32 s51, s52, 0
    buffer_load_dwordx4 v212, s[8:11], s51 offen lds
    s_add_u32 s50, s45, 1024
    s_mov_b32 m0, s50
    s_add_u32 s51, s52, 8192
    buffer_load_dwordx4 v213, s[8:11], s51 offen lds
    s_add_u32 s50, s45, 2048
    s_mov_b32 m0, s50
    s_add_u32 s51, s52, 16384
    buffer_load_dwordx4 v212, s[8:11], s51 offen lds
    s_add_u32 s50, s45, 3072
    s_mov_b32 m0, s50
    s_add_u32 s51, s52, 24576
    buffer_load_dwordx4 v213, s[8:11], s51 offen lds
    s_waitcnt vmcnt(20)
    ds_read_b64_tr_b16 v[80:81], v214 offset:16384
    ds_read_b64_tr_b16 v[82:83], v214 offset:16896
    v_mfma_f32_16x16x32_bf16 v[112:115], v[96:99], v[28:31], v[112:115]
    ds_read_b64_tr_b16 v[84:85], v215 offset:16384
    ds_read_b64_tr_b16 v[86:87], v215 offset:16896
    v_mfma_f32_16x16x32_bf16 v[116:119], v[100:103], v[28:31], v[116:119]
    ds_read_b64_tr_b16 v[88:89], v216 offset:16384
    ds_read_b64_tr_b16 v[90:91], v216 offset:16896
    v_mfma_f32_16x16x32_bf16 v[120:123], v[104:107], v[28:31], v[120:123]
    ds_read_b64_tr_b16 v[92:93], v217 offset:16384
    ds_read_b64_tr_b16 v[94:95], v217 offset:16896
    v_mfma_f32_16x16x32_bf16 v[124:127], v[108:111], v[28:31], v[124:127]
    s_lshl_b32 s52, s47, 12
    s_add_u32 s47, s47, 1
    s_cmp_ge_u32 s47, 14
    s_cselect_b32 s47, 0, s47
    v_add_u32 v253, s52, v211
    global_load_dwordx4 v[64:67], v253, s[4:5] offset:0 sc1
    global_load_dwordx4 v[68:71], v253, s[4:5] offset:1024 sc1
    global_load_dwordx4 v[72:75], v253, s[4:5] offset:2048 sc1
    global_load_dwordx4 v[76:79], v253, s[4:5] offset:3072 sc1
    s_waitcnt vmcnt(19)
    ds_read_b64_tr_b16 v[96:97], v214 offset:20480
    ds_read_b64_tr_b16 v[98:99], v214 offset:20992
    s_waitcnt lgkmcnt(8)
    v_mfma_f32_16x16x32_bf16 v[112:115], v[80:83], v[32:35], v[112:115]
    ds_read_b64_tr_b16 v[100:101], v215 offset:20480
    ds_read_b64_tr_b16 v[102:103], v215 offset:20992
    s_waitcnt lgkmcnt(8)
    v_mfma_f32_16x16x32_bf16 v[116:119], v[84:87], v[32:35], v[116:119]
    ds_read_b64_tr_b16 v[104:105], v216 offset:20480
    ds_read_b64_tr_b16 v[106:107], v216 offset:20992
    s_waitcnt lgkmcnt(8)
    v_mfma_f32_16x16x32_bf16 v[120:123], v[88:91], v[32:35], v[120:123]
    ds_read_b64_tr_b16 v[108:109], v217 offset:20480
    ds_read_b64_tr_b16 v[110:111], v217 offset:20992
    s_waitcnt lgkmcnt(8)
    v_mfma_f32_16x16x32_bf16 v[124:127], v[92:95], v[32:35], v[124:127]
    s_waitcnt vmcnt(18)
    ds_read_b64_tr_b16 v[80:81], v214 offset:24576
    ds_read_b64_tr_b16 v[82:83], v214 offset:25088
    s_waitcnt lgkmcnt(8)
    v_mfma_f32_16x16x32_bf16 v[112:115], v[96:99], v[36:39], v[112:115]
    ds_read_b64_tr_b16 v[84:85], v215 offset:24576
    ds_read_b64_tr_b16 v[86:87], v215 offset:25088
    s_waitcnt lgkmcnt(8)
    v_mfma_f32_16x16x32_bf16 v[116:119], v[100:103], v[36:39], v[116:119]
    ds_read_b64_tr_b16 v[88:89], v216 offset:24576
    ds_read_b64_tr_b16 v[90:91], v216 offset:25088
    s_waitcnt lgkmcnt(8)
    v_mfma_f32_16x16x32_bf16 v[120:123], v[104:107], v[36:39], v[120:123]
    ds_read_b64_tr_b16 v[92:93], v217 offset:24576
    ds_read_b64_tr_b16 v[94:95], v217 offset:25088
    s_waitcnt lgkmcnt(8)
    v_mfma_f32_16x16x32_bf16 v[124:127], v[108:111], v[36:39], v[124:127]
    s_waitcnt vmcnt(17)
    ds_read_b64_tr_b16 v[96:97], v214 offset:28672
    ds_read_b64_tr_b16 v[98:99], v214 offset:29184
    s_waitcnt lgkmcnt(8)
    v_mfma_f32_16x16x32_bf16 v[112:115], v[80:83], v[40:43], v[112:115]
    ds_read_b64_tr_b16 v[100:101], v215 offset:28672
    ds_read_b64_tr_b16 v[102:103], v215 offset:29184
    s_waitcnt lgkmcnt(8)
    v_mfma_f32_16x16x32_bf16 v[116:119], v[84:87], v[40:43], v[116:119]
    ds_read_b64_tr_b16 v[104:105], v216 offset:28672
    ds_read_b64_tr_b16 v[106:107], v216 offset:29184
    s_waitcnt lgkmcnt(8)
    v_mfma_f32_16x16x32_bf16 v[120:123], v[88:91], v[40:43], v[120:123]
    ds_read_b64_tr_b16 v[108:109], v217 offset:28672
    ds_read_b64_tr_b16 v[110:111], v217 offset:29184
    s_waitcnt lgkmcnt(8)
    v_mfma_f32_16x16x32_bf16 v[124:127], v[92:95], v[40:43], v[124:127]
    s_waitcnt lgkmcnt(0)
    s_barrier
    s_mov_b32 s65, s46
    s_add_u32 s46, s46, 1
    s_cmp_ge_u32 s46, 14
    s_cselect_b32 s46, 0, s46
    s_lshl_b32 s52, s65, 17
    s_add_u32 s50, s45, 16384
    s_mov_b32 m0, s50
    s_add_u32 s51, s52, 0
    buffer_load_dwordx4 v212, s[8:11], s51 offen lds
    s_add_u32 s50, s45, 17408
    s_mov_b32 m0, s50
    s_add_u32 s51, s52, 8192
    buffer_load_dwordx4 v213, s[8:11], s51 offen lds
    s_add_u32 s50, s45, 18432
    s_mov_b32 m0, s50
    s_add_u32 s51, s52, 16384
    buffer_load_dwordx4 v212, s[8:11], s51 offen lds
    s_add_u32 s50, s45, 19456
    s_mov_b32 m0, s50
    s_add_u32 s51, s52, 24576
    buffer_load_dwordx4 v213, s[8:11], s51 offen lds
    s_waitcnt vmcnt(20)
    ds_read_b64_tr_b16 v[80:81], v214 offset:32768
    ds_read_b64_tr_b16 v[82:83], v214 offset:33280
    v_mfma_f32_16x16x32_bf16 v[112:115], v[96:99], v[44:47], v[112:115]
    ds_read_b64_tr_b16 v[84:85], v215 offset:32768
    ds_read_b64_tr_b16 v[86:87], v215 offset:33280
    v_mfma_f32_16x16x32_bf16 v[116:119], v[100:103], v[44:47], v[116:119]
    ds_read_b64_tr_b16 v[88:89], v216 offset:32768
    ds_read_b64_tr_b16 v[90:91], v216 offset:33280
    v_mfma_f32_16x16x32_bf16 v[120:123], v[104:107], v[44:47], v[120:123]
    ds_read_b64_tr_b16 v[92:93], v217 offset:32768
    ds_read_b64_tr_b16 v[94:95], v217 offset:33280
    v_mfma_f32_16x16x32_bf16 v[124:127], v[108:111], v[44:47], v[124:127]
    s_lshl_b32 s52, s47, 12
    s_add_u32 s47, s47, 1
    s_cmp_ge_u32 s47, 14
    s_cselect_b32 s47, 0, s47
    v_add_u32 v253, s52, v211
    global_load_dwordx4 v[16:19], v253, s[4:5] offset:0 sc1
    global_load_dwordx4 v[20:23], v253, s[4:5] offset:1024 sc1
    global_load_dwordx4 v[24:27], v253, s[4:5] offset:2048 sc1
    global_load_dwordx4 v[28:31], v253, s[4:5] offset:3072 sc1
    s_waitcnt vmcnt(19)
    ds_read_b64_tr_b16 v[96:97], v214 offset:36864
    ds_read_b64_tr_b16 v[98:99], v214 offset:37376
    s_waitcnt lgkmcnt(8)
    v_mfma_f32_16x16x32_bf16 v[112:115], v[80:83], v[48:51], v[112:115]
    ds_read_b64_tr_b16 v[100:101], v215 offset:36864
    ds_read_b64_tr_b16 v[102:103], v215 offset:37376
    s_waitcnt lgkmcnt(8)
    v_mfma_f32_16x16x32_bf16 v[116:119], v[84:87], v[48:51], v[116:119]
    ds_read_b64_tr_b16 v[104:105], v216 offset:36864
    ds_read_b64_tr_b16 v[106:107], v216 offset:37376
    s_waitcnt lgkmcnt(8)
    v_mfma_f32_16x16x32_bf16 v[120:123], v[88:91], v[48:51], v[120:123]
    ds_read_b64_tr_b16 v[108:109], v217 offset:36864
    ds_read_b64_tr_b16 v[110:111], v217 offset:37376
    s_waitcnt lgkmcnt(8)
    v_mfma_f32_16x16x32_bf16 v[124:127], v[92:95], v[48:51], v[124:127]
    s_waitcnt vmcnt(18)
    ds_read_b64_tr_b16 v[80:81], v214 offset:40960
    ds_read_b64_tr_b16 v[82:83], v214 offset:41472
    s_waitcnt lgkmcnt(8)
    v_mfma_f32_16x16x32_bf16 v[112:115], v[96:99], v[52:55], v[112:115]
    ds_read_b64_tr_b16 v[84:85], v215 offset:40960
    ds_read_b64_tr_b16 v[86:87], v215 offset:41472
    s_waitcnt lgkmcnt(8)
    v_mfma_f32_16x16x32_bf16 v[116:119], v[100:103], v[52:55], v[116:119]
    ds_read_b64_tr_b16 v[88:89], v216 offset:40960
    ds_read_b64_tr_b16 v[90:91], v216 offset:41472
    s_waitcnt lgkmcnt(8)
    v_mfma_f32_16x16x32_bf16 v[120:123], v[104:107], v[52:55], v[120:123]
    ds_read_b64_tr_b16 v[92:93], v217 offset:40960
    ds_read_b64_tr_b16 v[94:95], v217 offset:41472
    s_waitcnt lgkmcnt(8)
    v_mfma_f32_16x16x32_bf16 v[124:127], v[108:111], v[52:55], v[124:127]
    s_waitcnt vmcnt(17)
    ds_read_b64_tr_b16 v[96:97], v214 offset:45056
    ds_read_b64_tr_b16 v[98:99], v214 offset:45568
    s_waitcnt lgkmcnt(8)
    v_mfma_f32_16x16x32_bf16 v[112:115], v[80:83], v[56:59], v[112:115]
    ds_read_b64_tr_b16 v[100:101], v215 offset:45056
    ds_read_b64_tr_b16 v[102:103], v215 offset:45568
    s_waitcnt lgkmcnt(8)
    v_mfma_f32_16x16x32_bf16 v[116:119], v[84:87], v[56:59], v[116:119]
    ds_read_b64_tr_b16 v[104:105], v216 offset:45056
    ds_read_b64_tr_b16 v[106:107], v216 offset:45568
    s_waitcnt lgkmcnt(8)
    v_mfma_f32_16x16x32_bf16 v[120:123], v[88:91], v[56:59], v[120:123]
    ds_read_b64_tr_b16 v[108:109], v217 offset:45056
    ds_read_b64_tr_b16 v[110:111], v217 offset:45568
    s_waitcnt lgkmcnt(8)
    v_mfma_f32_16x16x32_bf16 v[124:127], v[92:95], v[56:59], v[124:127]
    s_waitcnt lgkmcnt(0)
    s_barrier
    s_waitcnt vmcnt(16)
    ds_read_b64_tr_b16 v[80:81], v214 offset:49152
    ds_read_b64_tr_b16 v[82:83], v214 offset:49664
    v_mfma_f32_16x16x32_bf16 v[112:115], v[96:99], v[60:63], v[112:115]
    ds_read_b64_tr_b16 v[84:85], v215 offset:49152
    ds_read_b64_tr_b16 v[86:87], v215 offset:49664
    v_mfma_f32_16x16x32_bf16 v[116:119], v[100:103], v[60:63], v[116:119]
    ds_read_b64_tr_b16 v[88:89], v216 offset:49152
    ds_read_b64_tr_b16 v[90:91], v216 offset:49664
    v_mfma_f32_16x16x32_bf16 v[120:123], v[104:107], v[60:63], v[120:123]
    ds_read_b64_tr_b16 v[92:93], v217 offset:49152
    ds_read_b64_tr_b16 v[94:95], v217 offset:49664
    v_mfma_f32_16x16x32_bf16 v[124:127], v[108:111], v[60:63], v[124:127]
    s_lshl_b32 s52, s47, 12
    s_add_u32 s47, s47, 1
    s_cmp_ge_u32 s47, 14
    s_cselect_b32 s47, 0, s47
    v_add_u32 v253, s52, v211
    global_load_dwordx4 v[32:35], v253, s[4:5] offset:0 sc1
    global_load_dwordx4 v[36:39], v253, s[4:5] offset:1024 sc1
    global_load_dwordx4 v[40:43], v253, s[4:5] offset:2048 sc1
    global_load_dwordx4 v[44:47], v253, s[4:5] offset:3072 sc1
    s_waitcnt vmcnt(15)
    ds_read_b64_tr_b16 v[96:97], v214 offset:53248
    ds_read_b64_tr_b16 v[98:99], v214 offset:53760
    s_waitcnt lgkmcnt(8)
    v_mfma_f32_16x16x32_bf16 v[112:115], v[80:83], v[64:67], v[112:115]
    ds_read_b64_tr_b16 v[100:101], v215 offset:53248
    ds_read_b64_tr_b16 v[102:103], v215 offset:53760
    s_waitcnt lgkmcnt(8)
    v_mfma_f32_16x16x32_bf16 v[116:119], v[84:87], v[64:67], v[116:119]
    ds_read_b64_tr_b16 v[104:105], v216 offset:53248
    ds_read_b64_tr_b16 v[106:107], v216 offset:53760
    s_waitcnt lgkmcnt(8)
    v_mfma_f32_16x16x32_bf16 v[120:123], v[88:91], v[64:67], v[120:123]
    ds_read_b64_tr_b16 v[108:109], v217 offset:53248
    ds_read_b64_tr_b16 v[110:111], v217 offset:53760
    s_waitcnt lgkmcnt(8)
    v_mfma_f32_16x16x32_bf16 v[124:127], v[92:95], v[64:67], v[124:127]
    s_waitcnt vmcnt(14)
    ds_read_b64_tr_b16 v[80:81], v214 offset:57344
    ds_read_b64_tr_b16 v[82:83], v214 offset:57856
    s_waitcnt lgkmcnt(8)
    v_mfma_f32_16x16x32_bf16 v[112:115], v[96:99], v[68:71], v[112:115]
    ds_read_b64_tr_b16 v[84:85], v215 offset:57344
    ds_read_b64_tr_b16 v[86:87], v215 offset:57856
    s_waitcnt lgkmcnt(8)
    v_mfma_f32_16x16x32_bf16 v[116:119], v[100:103], v[68:71], v[116:119]
    ds_read_b64_tr_b16 v[88:89], v216 offset:57344
    ds_read_b64_tr_b16 v[90:91], v216 offset:57856
    s_waitcnt lgkmcnt(8)
    v_mfma_f32_16x16x32_bf16 v[120:123], v[104:107], v[68:71], v[120:123]
    ds_read_b64_tr_b16 v[92:93], v217 offset:57344
    ds_read_b64_tr_b16 v[94:95], v217 offset:57856
    s_waitcnt lgkmcnt(8)
    v_mfma_f32_16x16x32_bf16 v[124:127], v[108:111], v[68:71], v[124:127]
    s_waitcnt vmcnt(13)
    ds_read_b64_tr_b16 v[96:97], v214 offset:61440
    ds_read_b64_tr_b16 v[98:99], v214 offset:61952
    s_waitcnt lgkmcnt(8)
    v_mfma_f32_16x16x32_bf16 v[112:115], v[80:83], v[72:75], v[112:115]
    ds_read_b64_tr_b16 v[100:101], v215 offset:61440
    ds_read_b64_tr_b16 v[102:103], v215 offset:61952
    s_waitcnt lgkmcnt(8)
    v_mfma_f32_16x16x32_bf16 v[116:119], v[84:87], v[72:75], v[116:119]
    ds_read_b64_tr_b16 v[104:105], v216 offset:61440
    ds_read_b64_tr_b16 v[106:107], v216 offset:61952
    s_waitcnt lgkmcnt(8)
    v_mfma_f32_16x16x32_bf16 v[120:123], v[88:91], v[72:75], v[120:123]
    ds_read_b64_tr_b16 v[108:109], v217 offset:61440
    ds_read_b64_tr_b16 v[110:111], v217 offset:61952
    s_waitcnt lgkmcnt(8)
    v_mfma_f32_16x16x32_bf16 v[124:127], v[92:95], v[72:75], v[124:127]
    s_waitcnt lgkmcnt(0)
    s_barrier
    s_cmp_lg_u32 s22, 0
    s_cbranch_scc1 L_poll_a_skip
    s_add_u32 s50, s30, 32
    s_lshl_b32 s50, s50, 8
    s_add_u32 s50, s18, s50
    s_addc_u32 s51, s19, 0
    s_mov_b32 s55, 0
L_poll_a_loop:
    global_load_dword v252, v250, s[50:51] sc1
    s_waitcnt vmcnt(0)
    v_readfirstlane_b32 s54, v252
    s_nop 0
    s_cmp_ge_u32 s54, 32
    s_cbranch_scc1 L_poll_a_ok
    s_add_u32 s55, s55, 1
    s_cmp_ge_u32 s55, 0x40000
    s_cbranch_scc1 L_poll_a_ok
    s_sleep 2
    s_branch L_poll_a_loop
L_poll_a_ok:
L_poll_a_skip:
    s_waitcnt vmcnt(12)
    ds_read_b64_tr_b16 v[80:81], v214 offset:0
    ds_read_b64_tr_b16 v[82:83], v214 offset:512
    v_mfma_f32_16x16x32_bf16 v[112:115], v[96:99], v[76:79], v[112:115]
    ds_read_b64_tr_b16 v[84:85], v215 offset:0
    ds_read_b64_tr_b16 v[86:87], v215 offset:512
    v_mfma_f32_16x16x32_bf16 v[116:119], v[100:103], v[76:79], v[116:119]
    ds_read_b64_tr_b16 v[88:89], v216 offset:0
    ds_read_b64_tr_b16 v[90:91], v216 offset:512
    v_mfma_f32_16x16x32_bf16 v[120:123], v[104:107], v[76:79], v[120:123]
    ds_read_b64_tr_b16 v[92:93], v217 offset:0
    ds_read_b64_tr_b16 v[94:95], v217 offset:512
    v_mfma_f32_16x16x32_bf16 v[124:127], v[108:111], v[76:79], v[124:127]
    s_waitcnt vmcnt(7)
    ds_read_b64_tr_b16 v[96:97], v214 offset:4096
    ds_read_b64_tr_b16 v[98:99], v214 offset:4608
    s_waitcnt lgkmcnt(8)
    v_mfma_f32_16x16x32_bf16 v[112:115], v[80:83], v[16:19], v[112:115]
    ds_read_b64_tr_b16 v[100:101], v215 offset:4096
    ds_read_b64_tr_b16 v[102:103], v215 offset:4608
    s_waitcnt lgkmcnt(8)
    v_mfma_f32_16x16x32_bf16 v[116:119], v[84:87], v[16:19], v[116:119]
    ds_read_b64_tr_b16 v[104:105], v216 offset:4096
    ds_read_b64_tr_b16 v[106:107], v216 offset:4608
    s_waitcnt lgkmcnt(8)
    v_mfma_f32_16x16x32_bf16 v[120:123], v[88:91], v[16:19], v[120:123]
    ds_read_b64_tr_b16 v[108:109], v217 offset:4096
    ds_read_b64_tr_b16 v[110:111], v217 offset:4608
    s_waitcnt lgkmcnt(8)
    v_mfma_f32_16x16x32_bf16 v[124:127], v[92:95], v[16:19], v[124:127]
    s_waitcnt vmcnt(6)
    ds_read_b64_tr_b16 v[80:81], v214 offset:8192
    ds_read_b64_tr_b16 v[82:83], v214 offset:8704
    s_waitcnt lgkmcnt(8)
    v_mfma_f32_16x16x32_bf16 v[112:115], v[96:99], v[20:23], v[112:115]
    ds_read_b64_tr_b16 v[84:85], v215 offset:8192
    ds_read_b64_tr_b16 v[86:87], v215 offset:8704
    s_waitcnt lgkmcnt(8)
    v_mfma_f32_16x16x32_bf16 v[116:119], v[100:103], v[20:23], v[116:119]
    ds_read_b64_tr_b16 v[88:89], v216 offset:8192
    ds_read_b64_tr_b16 v[90:91], v216 offset:8704
    s_waitcnt lgkmcnt(8)
    v_mfma_f32_16x16x32_bf16 v[120:123], v[104:107], v[20:23], v[120:123]
    ds_read_b64_tr_b16 v[92:93], v217 offset:8192
    ds_read_b64_tr_b16 v[94:95], v217 offset:8704
    s_waitcnt lgkmcnt(8)
    v_mfma_f32_16x16x32_bf16 v[124:127], v[108:111], v[20:23], v[124:127]
    s_waitcnt vmcnt(5)
    ds_read_b64_tr_b16 v[96:97], v214 offset:12288
    ds_read_b64_tr_b16 v[98:99], v214 offset:12800
    s_waitcnt lgkmcnt(8)
    v_mfma_f32_16x16x32_bf16 v[112:115], v[80:83], v[24:27], v[112:115]
    ds_read_b64_tr_b16 v[100:101], v215 offset:12288
    ds_read_b64_tr_b16 v[102:103], v215 offset:12800
    s_waitcnt lgkmcnt(8)
    v_mfma_f32_16x16x32_bf16 v[116:119], v[84:87], v[24:27], v[116:119]
    ds_read_b64_tr_b16 v[104:105], v216 offset:12288
    ds_read_b64_tr_b16 v[106:107], v216 offset:12800
    s_waitcnt lgkmcnt(8)
    v_mfma_f32_16x16x32_bf16 v[120:123], v[88:91], v[24:27], v[120:123]
    ds_read_b64_tr_b16 v[108:109], v217 offset:12288
    ds_read_b64_tr_b16 v[110:111], v217 offset:12800
    s_waitcnt lgkmcnt(8)
    v_mfma_f32_16x16x32_bf16 v[124:127], v[92:95], v[24:27], v[124:127]
    s_waitcnt lgkmcnt(0)
    s_barrier
    global_load_dwordx2 v[128:129], v218, s[6:7] offset:0
    global_load_dwordx2 v[130:131], v218, s[6:7] offset:32
    global_load_dwordx2 v[132:133], v218, s[6:7] offset:64
    global_load_dwordx2 v[134:135], v218, s[6:7] offset:96
    s_lshl_b32 s50, s22, 11
    s_add_u32 s50, s50, 65536
    s_mov_b32 m0, s50
    s_mov_b32 s51, 0
    buffer_load_dwordx4 v219, s[12:15], s51 offen sc1 lds
    s_lshl_b32 s50, s22, 11
    s_add_u32 s50, s50, 66560
    s_mov_b32 m0, s50
    s_mov_b32 s51, 32768
    buffer_load_dwordx4 v219, s[12:15], s51 offen sc1 lds
    s_waitcnt vmcnt(10)
    ds_read_b64_tr_b16 v[80:81], v214 offset:16384
    ds_read_b64_tr_b16 v[82:83], v214 offset:16896
    v_mfma_f32_16x16x32_bf16 v[112:115], v[96:99], v[28:31], v[112:115]
    ds_read_b64_tr_b16 v[84:85], v215 offset:16384
    ds_read_b64_tr_b16 v[86:87], v215 offset:16896
    v_mfma_f32_16x16x32_bf16 v[116:119], v[100:103], v[28:31], v[116:119]
    ds_read_b64_tr_b16 v[88:89], v216 offset:16384
    ds_read_b64_tr_b16 v[90:91], v216 offset:16896
    v_mfma_f32_16x16x32_bf16 v[120:123], v[104:107], v[28:31], v[120:123]
    ds_read_b64_tr_b16 v[92:93], v217 offset:16384
    ds_read_b64_tr_b16 v[94:95], v217 offset:16896
    v_mfma_f32_16x16x32_bf16 v[124:127], v[108:111], v[28:31], v[124:127]
    s_waitcnt vmcnt(9)
    ds_read_b64_tr_b16 v[96:97], v214 offset:20480
    ds_read_b64_tr_b16 v[98:99], v214 offset:20992
    s_waitcnt lgkmcnt(8)
    v_mfma_f32_16x16x32_bf16 v[112:115], v[80:83], v[32:35], v[112:115]
    ds_read_b64_tr_b16 v[100:101], v215 offset:20480
    ds_read_b64_tr_b16 v[102:103], v215 offset:20992
    s_waitcnt lgkmcnt(8)
    v_mfma_f32_16x16x32_bf16 v[116:119], v[84:87], v[32:35], v[116:119]
    ds_read_b64_tr_b16 v[104:105], v216 offset:20480
    ds_read_b64_tr_b16 v[106:107], v216 offset:20992
    s_waitcnt lgkmcnt(8)
    v_mfma_f32_16x16x32_bf16 v[120:123], v[88:91], v[32:35], v[120:123]
    ds_read_b64_tr_b16 v[108:109], v217 offset:20480
    ds_read_b64_tr_b16 v[110:111], v217 offset:20992
    s_waitcnt lgkmcnt(8)
    v_mfma_f32_16x16x32_bf16 v[124:127], v[92:95], v[32:35], v[124:127]
    s_waitcnt vmcnt(8)
    ds_read_b64_tr_b16 v[80:81], v214 offset:24576
    ds_read_b64_tr_b16 v[82:83], v214 offset:25088
    s_waitcnt lgkmcnt(8)
    v_mfma_f32_16x16x32_bf16 v[112:115], v[96:99], v[36:39], v[112:115]
    ds_read_b64_tr_b16 v[84:85], v215 offset:24576
    ds_read_b64_tr_b16 v[86:87], v215 offset:25088
    s_waitcnt lgkmcnt(8)
    v_mfma_f32_16x16x32_bf16 v[116:119], v[100:103], v[36:39], v[116:119]
    ds_read_b64_tr_b16 v[88:89], v216 offset:24576
    ds_read_b64_tr_b16 v[90:91], v216 offset:25088
    s_waitcnt lgkmcnt(8)
    v_mfma_f32_16x16x32_bf16 v[120:123], v[104:107], v[36:39], v[120:123]
    ds_read_b64_tr_b16 v[92:93], v217 offset:24576
    ds_read_b64_tr_b16 v[94:95], v217 offset:25088
    s_waitcnt lgkmcnt(8)
    v_mfma_f32_16x16x32_bf16 v[124:127], v[108:111], v[36:39], v[124:127]
    s_waitcnt vmcnt(7)
    ds_read_b64_tr_b16 v[96:97], v214 offset:28672
    ds_read_b64_tr_b16 v[98:99], v214 offset:29184
    s_waitcnt lgkmcnt(8)
    v_mfma_f32_16x16x32_bf16 v[112:115], v[80:83], v[40:43], v[112:115]
    ds_read_b64_tr_b16 v[100:101], v215 offset:28672
    ds_read_b64_tr_b16 v[102:103], v215 offset:29184
    s_waitcnt lgkmcnt(8)
    v_mfma_f32_16x16x32_bf16 v[116:119], v[84:87], v[40:43], v[116:119]
    ds_read_b64_tr_b16 v[104:105], v216 offset:28672
    ds_read_b64_tr_b16 v[106:107], v216 offset:29184
    s_waitcnt lgkmcnt(8)
    v_mfma_f32_16x16x32_bf16 v[120:123], v[88:91], v[40:43], v[120:123]
    ds_read_b64_tr_b16 v[108:109], v217 offset:28672
    ds_read_b64_tr_b16 v[110:111], v217 offset:29184
    s_waitcnt lgkmcnt(8)
    v_mfma_f32_16x16x32_bf16 v[124:127], v[92:95], v[40:43], v[124:127]
    s_waitcnt vmcnt(6)
    s_waitcnt lgkmcnt(6)
    v_mfma_f32_16x16x32_bf16 v[112:115], v[96:99], v[44:47], v[112:115]
    s_waitcnt lgkmcnt(4)
    v_mfma_f32_16x16x32_bf16 v[116:119], v[100:103], v[44:47], v[116:119]
    s_waitcnt lgkmcnt(2)
    v_mfma_f32_16x16x32_bf16 v[120:123], v[104:107], v[44:47], v[120:123]
    s_waitcnt lgkmcnt(0)
    v_mfma_f32_16x16x32_bf16 v[124:127], v[108:111], v[44:47], v[124:127]
    s_waitcnt vmcnt(0)
    s_barrier
    v_lshlrev_b32 v12, 9, v3
    v_lshl_add_u32 v12, v4, 1, v12
    s_lshl_b32 s51, s22, 5
    s_add_u32 s50, s51, 65536
    v_add_u32 v12, s50, v12
    ds_read_u16 v16, v12 offset:0
    ds_read_u16 v17, v12 offset:128
    ds_read_u16 v18, v12 offset:256
    ds_read_u16 v19, v12 offset:384
    ds_read_u16 v20, v12 offset:2048
    ds_read_u16 v21, v12 offset:2176
    ds_read_u16 v22, v12 offset:2304
    ds_read_u16 v23, v12 offset:2432
    ds_read_u16 v24, v12 offset:4096
    ds_read_u16 v25, v12 offset:4224
    ds_read_u16 v26, v12 offset:4352
    ds_read_u16 v27, v12 offset:4480
    ds_read_u16 v28, v12 offset:6144
    ds_read_u16 v29, v12 offset:6272
    ds_read_u16 v30, v12 offset:6400
    ds_read_u16 v31, v12 offset:6528
    s_waitcnt lgkmcnt(12)
    v_cvt_pk_bf16_f32 v48, v112, v113
    v_lshlrev_b32 v112, 16, v48
    v_and_b32 v113, 0xffff0000, v48
    v_lshlrev_b32 v49, 16, v128
    v_and_b32 v50, 0xffff0000, v128
    v_lshlrev_b32 v51, 16, v16
    v_lshlrev_b32 v52, 16, v17
    v_add_f32 v49, v49, v51
    v_add_f32 v50, v50, v52
    v_cvt_pk_bf16_f32 v48, v49, v50
    v_lshlrev_b32 v49, 16, v48
    v_and_b32 v50, 0xffff0000, v48
    v_add_f32 v49, v49, v112
    v_add_f32 v50, v50, v113
    v_cvt_pk_bf16_f32 v54, v49, v50
    v_cvt_pk_bf16_f32 v48, v114, v115
    v_lshlrev_b32 v114, 16, v48
    v_and_b32 v115, 0xffff0000, v48
    v_lshlrev_b32 v49, 16, v129
    v_and_b32 v50, 0xffff0000, v129
    v_lshlrev_b32 v51, 16, v18
    v_lshlrev_b32 v52, 16, v19
    v_add_f32 v49, v49, v51
    v_add_f32 v50, v50, v52
    v_cvt_pk_bf16_f32 v48, v49, v50
    v_lshlrev_b32 v49, 16, v48
    v_and_b32 v50, 0xffff0000, v48
    v_add_f32 v49, v49, v114
    v_add_f32 v50, v50, v115
    v_cvt_pk_bf16_f32 v55, v49, v50
    global_store_dwordx2 v218, v[54:55], s[62:63] offset:0
    s_waitcnt lgkmcnt(8)
    v_cvt_pk_bf16_f32 v48, v116, v117
    v_lshlrev_b32 v116, 16, v48
    v_and_b32 v117, 0xffff0000, v48
    v_lshlrev_b32 v49, 16, v130
    v_and_b32 v50, 0xffff0000, v130
    v_lshlrev_b32 v51, 16, v20
    v_lshlrev_b32 v52, 16, v21
    v_add_f32 v49, v49, v51
    v_add_f32 v50, v50, v52
    v_cvt_pk_bf16_f32 v48, v49, v50
    v_lshlrev_b32 v49, 16, v48
    v_and_b32 v50, 0xffff0000, v48
    v_add_f32 v49, v49, v116
    v_add_f32 v50, v50, v117
    v_cvt_pk_bf16_f32 v56, v49, v50
    v_cvt_pk_bf16_f32 v48, v118, v119
    v_lshlrev_b32 v118, 16, v48
    v_and_b32 v119, 0xffff0000, v48
    v_lshlrev_b32 v49, 16, v131
    v_and_b32 v50, 0xffff0000, v131
    v_lshlrev_b32 v51, 16, v22
    v_lshlrev_b32 v52, 16, v23
    v_add_f32 v49, v49, v51
    v_add_f32 v50, v50, v52
    v_cvt_pk_bf16_f32 v48, v49, v50
    v_lshlrev_b32 v49, 16, v48
    v_and_b32 v50, 0xffff0000, v48
    v_add_f32 v49, v49, v118
    v_add_f32 v50, v50, v119
    v_cvt_pk_bf16_f32 v57, v49, v50
    global_store_dwordx2 v218, v[56:57], s[62:63] offset:32
    s_waitcnt lgkmcnt(4)
    v_cvt_pk_bf16_f32 v48, v120, v121
    v_lshlrev_b32 v120, 16, v48
    v_and_b32 v121, 0xffff0000, v48
    v_lshlrev_b32 v49, 16, v132
    v_and_b32 v50, 0xffff0000, v132
    v_lshlrev_b32 v51, 16, v24
    v_lshlrev_b32 v52, 16, v25
    v_add_f32 v49, v49, v51
    v_add_f32 v50, v50, v52
    v_cvt_pk_bf16_f32 v48, v49, v50
    v_lshlrev_b32 v49, 16, v48
    v_and_b32 v50, 0xffff0000, v48
    v_add_f32 v49, v49, v120
    v_add_f32 v50, v50, v121
    v_cvt_pk_bf16_f32 v54, v49, v50
    v_cvt_pk_bf16_f32 v48, v122, v123
    v_lshlrev_b32 v122, 16, v48
    v_and_b32 v123, 0xffff0000, v48
    v_lshlrev_b32 v49, 16, v133
    v_and_b32 v50, 0xffff0000, v133
    v_lshlrev_b32 v51, 16, v26
    v_lshlrev_b32 v52, 16, v27
    v_add_f32 v49, v49, v51
    v_add_f32 v50, v50, v52
    v_cvt_pk_bf16_f32 v48, v49, v50
    v_lshlrev_b32 v49, 16, v48
    v_and_b32 v50, 0xffff0000, v48
    v_add_f32 v49, v49, v122
    v_add_f32 v50, v50, v123
    v_cvt_pk_bf16_f32 v55, v49, v50
    global_store_dwordx2 v218, v[54:55], s[62:63] offset:64
    s_waitcnt lgkmcnt(0)
    v_cvt_pk_bf16_f32 v48, v124, v125
    v_lshlrev_b32 v124, 16, v48
    v_and_b32 v125, 0xffff0000, v48
    v_lshlrev_b32 v49, 16, v134
    v_and_b32 v50, 0xffff0000, v134
    v_lshlrev_b32 v51, 16, v28
    v_lshlrev_b32 v52, 16, v29
    v_add_f32 v49, v49, v51
    v_add_f32 v50, v50, v52
    v_cvt_pk_bf16_f32 v48, v49, v50
    v_lshlrev_b32 v49, 16, v48
    v_and_b32 v50, 0xffff0000, v48
    v_add_f32 v49, v49, v124
    v_add_f32 v50, v50, v125
    v_cvt_pk_bf16_f32 v56, v49, v50
    v_cvt_pk_bf16_f32 v48, v126, v127
    v_lshlrev_b32 v126, 16, v48
    v_and_b32 v127, 0xffff0000, v48
    v_lshlrev_b32 v49, 16, v135
    v_and_b32 v50, 0xffff0000, v135
    v_lshlrev_b32 v51, 16, v30
    v_lshlrev_b32 v52, 16, v31
    v_add_f32 v49, v49, v51
    v_add_f32 v50, v50, v52
    v_cvt_pk_bf16_f32 v48, v49, v50
    v_lshlrev_b32 v49, 16, v48
    v_and_b32 v50, 0xffff0000, v48
    v_add_f32 v49, v49, v126
    v_add_f32 v50, v50, v127
    v_cvt_pk_bf16_f32 v57, v49, v50
    global_store_dwordx2 v218, v[56:57], s[62:63] offset:96
    s_branch L_done
L_roleS:
    s_sub_u32 s3, s2, 256
    s_lshr_b32 s23, s22, 1
    s_and_b32 s24, s22, 1
    s_lshl_b32 s25, s3, 1
    s_add_u32 s25, s25, s23
    s_lshl_b32 s50, s25, 8
    s_lshl_b32 s51, s24, 7
    s_add_u32 s50, s50, s51
    v_lshlrev_b32 v6, 3, v3
    v_add_u32 v6, s50, v6
    s_lshl_b32 s52, s3, 2
    s_waitcnt lgkmcnt(0)
    s_add_u32 s18, s4, 25165824
    s_addc_u32 s19, s5, 0
    s_or_b32 s50, s3, s22
    s_cmp_lg_u32 s50, 0
    s_cbranch_scc1 L_nozero
    v_lshlrev_b32 v7, 8, v1
    global_store_dword v7, v250, s[18:19] sc1
    s_waitcnt vmcnt(0)
    s_mov_b64 exec, 1
    global_store_dword v250, v251, s[20:21] sc1
    s_mov_b64 exec, -1
L_nozero:
    global_load_dwordx2 v[16:17], v6, s[64:65] offset:0
    global_load_dwordx2 v[18:19], v6, s[66:67] offset:0
    global_load_dwordx2 v[20:21], v6, s[68:69] offset:0
    global_load_dwordx2 v[22:23], v6, s[70:71] offset:0
    global_load_dwordx2 v[24:25], v6, s[72:73] offset:0
    global_load_dwordx2 v[26:27], v6, s[74:75] offset:0
    global_load_dwordx2 v[28:29], v6, s[64:65] offset:32
    global_load_dwordx2 v[30:31], v6, s[66:67] offset:32
    global_load_dwordx2 v[32:33], v6, s[68:69] offset:32
    global_load_dwordx2 v[34:35], v6, s[70:71] offset:32
    global_load_dwordx2 v[36:37], v6, s[72:73] offset:32
    global_load_dwordx2 v[38:39], v6, s[74:75] offset:32
    global_load_dwordx2 v[40:41], v6, s[64:65] offset:64
    global_load_dwordx2 v[42:43], v6, s[66:67] offset:64
    global_load_dwordx2 v[44:45], v6, s[68:69] offset:64
    global_load_dwordx2 v[46:47], v6, s[70:71] offset:64
    global_load_dwordx2 v[48:49], v6, s[72:73] offset:64
    global_load_dwordx2 v[50:51], v6, s[74:75] offset:64
    global_load_dwordx2 v[52:53], v6, s[64:65] offset:96
    global_load_dwordx2 v[54:55], v6, s[66:67] offset:96
    global_load_dwordx2 v[56:57], v6, s[68:69] offset:96
    global_load_dwordx2 v[58:59], v6, s[70:71] offset:96
    global_load_dwordx2 v[60:61], v6, s[72:73] offset:96
    global_load_dwordx2 v[62:63], v6, s[74:75] offset:96
    s_load_dword s53, s[76:77], s52
    s_load_dword s33, s[78:79], s52
    s_mov_b32 s12, s4
    s_mov_b32 s13, s5
    s_mov_b32 s14, 0x10000000
    s_mov_b32 s15, 0x00020000
    v_lshlrev_b32 v5, 3, v4
    v_cvt_f32_u32 v5, v5
    v_lshrrev_b32 v6, 3, v4
    v_and_b32 v11, 7, v4
    v_lshl_add_u32 v6, v6, 7, v11
    v_cvt_f32_u32 v6, v6
    v_lshrrev_b32 v7, 2, v4
    v_lshlrev_b32 v7, 7, v7
    v_and_b32 v11, 3, v4
    v_lshl_add_u32 v7, v11, 1, v7
    v_add_u32 v7, 0x100, v7
    v_subrev_u32 v11, 8, v4
    v_lshrrev_b32 v11, 1, v11
    v_lshlrev_b32 v11, 7, v11
    v_and_b32 v12, 1, v4
    v_lshl_add_u32 v11, v12, 2, v11
    v_add_u32 v11, 0x200, v11
    v_cmp_gt_u32 vcc, 8, v4
    s_nop 1
    v_cndmask_b32 v7, v11, v7, vcc
    v_cvt_f32_u32 v7, v7
    v_lshlrev_b32 v8, 7, v4
    v_add_u32 v8, 0x400, v8
    v_cmp_gt_u32 vcc, 9, v4
    s_nop 1
    v_cndmask_b32 v8, 0, v8, vcc
    v_cvt_f32_u32 v8, v8
    v_lshlrev_b32 v180, 3, v0
    v_sub_u32 v180, 2047, v180
    v_cvt_f32_u32 v180, v180
    v_cvt_pk_bf16_f32 v180, v180, v180
    v_lshlrev_b32 v180, 16, v180
    v_cvt_u32_f32 v180, v180
    v_lshrrev_b32 v181, 7, v180
    v_and_b32 v182, 7, v180
    v_bfe_u32 v183, v180, 3, 4
    v_lshl_add_u32 v184, v181, 3, v182
    v_lshrrev_b32 v185, 1, v182
    v_lshl_add_u32 v185, v181, 2, v185
    v_add_u32 v185, 8, v185
    v_lshrrev_b32 v186, 2, v182
    v_lshl_add_u32 v186, v181, 1, v186
    v_add_u32 v186, 16, v186
    v_add_u32 v187, 24, v181
    v_cmp_gt_u32 vcc, 8, v181
    s_nop 1
    v_cndmask_b32 v187, v187, v186, vcc
    v_cmp_gt_u32 vcc, 4, v181
    s_nop 1
    v_cndmask_b32 v187, v187, v185, vcc
    v_cmp_gt_u32 vcc, 2, v181
    s_nop 1
    v_cndmask_b32 v187, v187, v184, vcc
    v_lshrrev_b32 v184, 2, v187
    v_lshl_add_u32 v184, v184, 4, v183
    v_lshlrev_b32 v184, 4, v184
    v_and_b32 v185, 3, v187
    v_lshl_add_u32 v184, v185, 2, v184
    v_add_u32 v200, 61952, v184
    v_lshlrev_b32 v180, 3, v0
    v_sub_u32 v180, 2046, v180
    v_cvt_f32_u32 v180, v180
    v_cvt_pk_bf16_f32 v180, v180, v180
    v_lshlrev_b32 v180, 16, v180
    v_cvt_u32_f32 v180, v180
    v_lshrrev_b32 v181, 7, v180
    v_and_b32 v182, 7, v180
    v_bfe_u32 v183, v180, 3, 4
    v_lshl_add_u32 v184, v181, 3, v182
    v_lshrrev_b32 v185, 1, v182
    v_lshl_add_u32 v185, v181, 2, v185
    v_add_u32 v185, 8, v185
    v_lshrrev_b32 v186, 2, v182
    v_lshl_add_u32 v186, v181, 1, v186
    v_add_u32 v186, 16, v186
    v_add_u32 v187, 24, v181
    v_cmp_gt_u32 vcc, 8, v181
    s_nop 1
    v_cndmask_b32 v187, v187, v186, vcc
    v_cmp_gt_u32 vcc, 4, v181
    s_nop 1
    v_cndmask_b32 v187, v187, v185, vcc
    v_cmp_gt_u32 vcc, 2, v181
    s_nop 1
    v_cndmask_b32 v187, v187, v184, vcc
    v_lshrrev_b32 v184, 2, v187
    v_lshl_add_u32 v184, v184, 4, v183
    v_lshlrev_b32 v184, 4, v184
    v_and_b32 v185, 3, v187
    v_lshl_add_u32 v184, v185, 2, v184
    v_add_u32 v201, 61952, v184
    v_lshlrev_b32 v180, 3, v0
    v_sub_u32 v180, 2045, v180
    v_cvt_f32_u32 v180, v180
    v_cvt_pk_bf16_f32 v180, v180, v180
    v_lshlrev_b32 v180, 16, v180
    v_cvt_u32_f32 v180, v180
    v_lshrrev_b32 v181, 7, v180
    v_and_b32 v182, 7, v180
    v_bfe_u32 v183, v180, 3, 4
    v_lshl_add_u32 v184, v181, 3, v182
    v_lshrrev_b32 v185, 1, v182
    v_lshl_add_u32 v185, v181, 2, v185
    v_add_u32 v185, 8, v185
    v_lshrrev_b32 v186, 2, v182
    v_lshl_add_u32 v186, v181, 1, v186
    v_add_u32 v186, 16, v186
    v_add_u32 v187, 24, v181
    v_cmp_gt_u32 vcc, 8, v181
    s_nop 1
    v_cndmask_b32 v187, v187, v186, vcc
    v_cmp_gt_u32 vcc, 4, v181
    s_nop 1
    v_cndmask_b32 v187, v187, v185, vcc
    v_cmp_gt_u32 vcc, 2, v181
    s_nop 1
    v_cndmask_b32 v187, v187, v184, vcc
    v_lshrrev_b32 v184, 2, v187
    v_lshl_add_u32 v184, v184, 4, v183
    v_lshlrev_b32 v184, 4, v184
    v_and_b32 v185, 3, v187
    v_lshl_add_u32 v184, v185, 2, v184
    v_add_u32 v202, 61952, v184
    v_lshlrev_b32 v180, 3, v0
    v_sub_u32 v180, 2044, v180
    v_cvt_f32_u32 v180, v180
    v_cvt_pk_bf16_f32 v180, v180, v180
    v_lshlrev_b32 v180, 16, v180
    v_cvt_u32_f32 v180, v180
    v_lshrrev_b32 v181, 7, v180
    v_and_b32 v182, 7, v180
    v_bfe_u32 v183, v180, 3, 4
    v_lshl_add_u32 v184, v181, 3, v182
    v_lshrrev_b32 v185, 1, v182
    v_lshl_add_u32 v185, v181, 2, v185
    v_add_u32 v185, 8, v185
    v_lshrrev_b32 v186, 2, v182
    v_lshl_add_u32 v186, v181, 1, v186
    v_add_u32 v186, 16, v186
    v_add_u32 v187, 24, v181
    v_cmp_gt_u32 vcc, 8, v181
    s_nop 1
    v_cndmask_b32 v187, v187, v186, vcc
    v_cmp_gt_u32 vcc, 4, v181
    s_nop 1
    v_cndmask_b32 v187, v187, v185, vcc
    v_cmp_gt_u32 vcc, 2, v181
    s_nop 1
    v_cndmask_b32 v187, v187, v184, vcc
    v_lshrrev_b32 v184, 2, v187
    v_lshl_add_u32 v184, v184, 4, v183
    v_lshlrev_b32 v184, 4, v184
    v_and_b32 v185, 3, v187
    v_lshl_add_u32 v184, v185, 2, v184
    v_add_u32 v203, 61952, v184
    v_lshlrev_b32 v180, 3, v0
    v_sub_u32 v180, 2043, v180
    v_cvt_f32_u32 v180, v180
    v_cvt_pk_bf16_f32 v180, v180, v180
    v_lshlrev_b32 v180, 16, v180
    v_cvt_u32_f32 v180, v180
    v_lshrrev_b32 v181, 7, v180
    v_and_b32 v182, 7, v180
    v_bfe_u32 v183, v180, 3, 4
    v_lshl_add_u32 v184, v181, 3, v182
    v_lshrrev_b32 v185, 1, v182
    v_lshl_add_u32 v185, v181, 2, v185
    v_add_u32 v185, 8, v185
    v_lshrrev_b32 v186, 2, v182
    v_lshl_add_u32 v186, v181, 1, v186
    v_add_u32 v186, 16, v186
    v_add_u32 v187, 24, v181
    v_cmp_gt_u32 vcc, 8, v181
    s_nop 1
    v_cndmask_b32 v187, v187, v186, vcc
    v_cmp_gt_u32 vcc, 4, v181
    s_nop 1
    v_cndmask_b32 v187, v187, v185, vcc
    v_cmp_gt_u32 vcc, 2, v181
    s_nop 1
    v_cndmask_b32 v187, v187, v184, vcc
    v_lshrrev_b32 v184, 2, v187
    v_lshl_add_u32 v184, v184, 4, v183
    v_lshlrev_b32 v184, 4, v184
    v_and_b32 v185, 3, v187
    v_lshl_add_u32 v184, v185, 2, v184
    v_add_u32 v204, 61952, v184
    v_lshlrev_b32 v180, 3, v0
    v_sub_u32 v180, 2042, v180
    v_cvt_f32_u32 v180, v180
    v_cvt_pk_bf16_f32 v180, v180, v180
    v_lshlrev_b32 v180, 16, v180
    v_cvt_u32_f32 v180, v180
    v_lshrrev_b32 v181, 7, v180
    v_and_b32 v182, 7, v180
    v_bfe_u32 v183, v180, 3, 4
    v_lshl_add_u32 v184, v181, 3, v182
    v_lshrrev_b32 v185, 1, v182
    v_lshl_add_u32 v185, v181, 2, v185
    v_add_u32 v185, 8, v185
    v_lshrrev_b32 v186, 2, v182
    v_lshl_add_u32 v186, v181, 1, v186
    v_add_u32 v186, 16, v186
    v_add_u32 v187, 24, v181
    v_cmp_gt_u32 vcc, 8, v181
    s_nop 1
    v_cndmask_b32 v187, v187, v186, vcc
    v_cmp_gt_u32 vcc, 4, v181
    s_nop 1
    v_cndmask_b32 v187, v187, v185, vcc
    v_cmp_gt_u32 vcc, 2, v181
    s_nop 1
    v_cndmask_b32 v187, v187, v184, vcc
    v_lshrrev_b32 v184, 2, v187
    v_lshl_add_u32 v184, v184, 4, v183
    v_lshlrev_b32 v184, 4, v184
    v_and_b32 v185, 3, v187
    v_lshl_add_u32 v184, v185, 2, v184
    v_add_u32 v205, 61952, v184
    v_lshlrev_b32 v180, 3, v0
    v_sub_u32 v180, 2041, v180
    v_cvt_f32_u32 v180, v180
    v_cvt_pk_bf16_f32 v180, v180, v180
    v_lshlrev_b32 v180, 16, v180
    v_cvt_u32_f32 v180, v180
    v_lshrrev_b32 v181, 7, v180
    v_and_b32 v182, 7, v180
    v_bfe_u32 v183, v180, 3, 4
    v_lshl_add_u32 v184, v181, 3, v182
    v_lshrrev_b32 v185, 1, v182
    v_lshl_add_u32 v185, v181, 2, v185
    v_add_u32 v185, 8, v185
    v_lshrrev_b32 v186, 2, v182
    v_lshl_add_u32 v186, v181, 1, v186
    v_add_u32 v186, 16, v186
    v_add_u32 v187, 24, v181
    v_cmp_gt_u32 vcc, 8, v181
    s_nop 1
    v_cndmask_b32 v187, v187, v186, vcc
    v_cmp_gt_u32 vcc, 4, v181
    s_nop 1
    v_cndmask_b32 v187, v187, v185, vcc
    v_cmp_gt_u32 vcc, 2, v181
    s_nop 1
    v_cndmask_b32 v187, v187, v184, vcc
    v_lshrrev_b32 v184, 2, v187
    v_lshl_add_u32 v184, v184, 4, v183
    v_lshlrev_b32 v184, 4, v184
    v_and_b32 v185, 3, v187
    v_lshl_add_u32 v184, v185, 2, v184
    v_add_u32 v206, 61952, v184
    v_lshlrev_b32 v180, 3, v0
    v_sub_u32 v180, 2040, v180
    v_cvt_f32_u32 v180, v180
    v_cvt_pk_bf16_f32 v180, v180, v180
    v_lshlrev_b32 v180, 16, v180
    v_cvt_u32_f32 v180, v180
    v_lshrrev_b32 v181, 7, v180
    v_and_b32 v182, 7, v180
    v_bfe_u32 v183, v180, 3, 4
    v_lshl_add_u32 v184, v181, 3, v182
    v_lshrrev_b32 v185, 1, v182
    v_lshl_add_u32 v185, v181, 2, v185
    v_add_u32 v185, 8, v185
    v_lshrrev_b32 v186, 2, v182
    v_lshl_add_u32 v186, v181, 1, v186
    v_add_u32 v186, 16, v186
    v_add_u32 v187, 24, v181
    v_cmp_gt_u32 vcc, 8, v181
    s_nop 1
    v_cndmask_b32 v187, v187, v186, vcc
    v_cmp_gt_u32 vcc, 4, v181
    s_nop 1
    v_cndmask_b32 v187, v187, v185, vcc
    v_cmp_gt_u32 vcc, 2, v181
    s_nop 1
    v_cndmask_b32 v187, v187, v184, vcc
    v_lshrrev_b32 v184, 2, v187
    v_lshl_add_u32 v184, v184, 4, v183
    v_lshlrev_b32 v184, 4, v184
    v_and_b32 v185, 3, v187
    v_lshl_add_u32 v184, v185, 2, v184
    v_add_u32 v207, 61952, v184
    v_and_b32 v12, 31, v1
    v_lshrrev_b32 v13, 5, v1
    v_and_b32 v14, 7, v12
    v_sub_u32 v14, 7, v14
    v_mul_u32_u24 v14, 4160, v14
    v_lshrrev_b32 v15, 3, v12
    v_sub_u32 v15, v13, v15
    v_add_u32 v15, 3, v15
    v_lshl_add_u32 v14, v15, 4, v14
    s_lshl_b32 s50, s22, 10
    s_sub_u32 s51, 3072, s50
    v_add_u32 v208, s51, v14
    s_lshl_b32 s50, s22, 9
    s_sub_u32 s51, 3584, s50
    v_add_u32 v209, s51, v14
    v_mul_u32_u24 v14, 80, v12
    v_lshl_add_u32 v15, v13, 4, v14
    s_mul_i32 s50, s22, 1280
    s_sub_u32 s51, 37712, s50
    v_add_u32 v210, s51, v15
    s_mul_i32 s50, s22, 640
    s_sub_u32 s51, 35792, s50
    v_add_u32 v211, s51, v15
    v_lshl_add_u32 v15, v13, 3, v14
    s_lshr_b32 s50, s22, 1
    s_mul_i32 s51, s50, 2560
    s_and_b32 s54, s22, 1
    s_lshl_b32 s54, s54, 5
    s_add_u32 s51, s51, s54
    s_add_u32 s51, s51, 36352
    v_add_u32 v212, s51, v15
    v_lshlrev_b32 v15, 6, v12
    v_lshl_add_u32 v15, v13, 4, v15
    s_lshl_b32 s51, s3, 13
    s_lshl_b32 s55, s50, 11
    s_add_u32 s51, s51, s55
    s_add_u32 s51, s51, s54
    s_add_u32 s51, s51, 16777216
    v_add_u32 v213, s51, v15
    v_lshlrev_b32 v15, 4, v1
    s_lshl_b32 s55, s22, 13
    v_add_u32 v214, s55, v15
    s_lshl_b32 s55, s22, 11
    v_add_u32 v215, s55, v15
    v_lshlrev_b32 v216, 4, v0
    v_add_u32 v217, 68096, v216
    s_waitcnt lgkmcnt(0)
    s_lshl_b32 s50, s23, 4
    s_lshr_b32 s53, s53, s50
    s_lshl_b32 s53, s53, 16
    s_lshl_b32 s34, s33, 16
    s_and_b32 s35, s33, 0xffff0000
    v_mov_b32 v9, s53
    v_mul_f32 v9, 0x3fb8aa3b, v9
    v_exp_f32 v9, v9
    s_nop 0
    v_cvt_pk_bf16_f32 v9, v9, v9
    v_lshlrev_b32 v9, 16, v9
    v_mov_b32 v128, 0
    v_mov_b32 v129, 0
    v_mov_b32 v130, 0
    v_mov_b32 v131, 0
    v_mov_b32 v132, 0
    v_mov_b32 v133, 0
    v_mov_b32 v134, 0
    v_mov_b32 v135, 0
    v_mov_b32 v136, 0
    v_mov_b32 v137, 0
    v_mov_b32 v138, 0
    v_mov_b32 v139, 0
    s_waitcnt vmcnt(18)
    v_lshlrev_b32 v160, 16, v16
    v_lshlrev_b32 v161, 16, v18
    v_lshlrev_b32 v162, 16, v20
    v_lshlrev_b32 v163, 16, v22
    v_lshlrev_b32 v164, 16, v24
    v_lshlrev_b32 v165, 16, v26
    v_mul_f32 v166, v9, v160
    v_mul_f32 v167, v9, v161
    v_mul_f32 v162, v9, v162
    v_mul_f32 v163, v9, v163
    v_mul_f32 v166, 0x3fb8aa3b, v166
    v_mul_f32 v167, 0x3e22f983, v167
    v_mul_f32 v168, v164, v162
    v_mul_f32 v169, v164, v163
    v_mul_f32 v140, v166, v5
    v_mul_f32 v141, v166, v6
    v_mul_f32 v142, v166, v7
    v_mul_f32 v143, v166, v8
    v_mul_f32 v144, v167, v5
    v_mul_f32 v145, v167, v6
    v_mul_f32 v146, v167, v7
    v_mul_f32 v147, v167, v8
    v_fma_f32 v168, -v165, v163, v168
    v_fma_f32 v169, v165, v162, v169
    v_exp_f32 v140, v140
    v_exp_f32 v141, v141
    v_exp_f32 v142, v142
    v_exp_f32 v143, v143
    v_fract_f32 v144, v144
    v_fract_f32 v145, v145
    v_fract_f32 v146, v146
    v_fract_f32 v147, v147
    v_cos_f32 v148, v144
    v_cos_f32 v149, v145
    v_cos_f32 v150, v146
    v_cos_f32 v151, v147
    v_sin_f32 v144, v144
    v_sin_f32 v145, v145
    v_sin_f32 v146, v146
    v_sin_f32 v147, v147
    v_mul_f32 v148, v148, v140
    v_mul_f32 v149, v149, v141
    v_mul_f32 v150, v150, v142
    v_mul_f32 v151, v151, v143
    v_mul_f32 v144, v144, v140
    v_mul_f32 v145, v145, v141
    v_mul_f32 v146, v146, v142
    v_mul_f32 v147, v147, v143
    v_mul_f32 v170, v168, v148
    v_mul_f32 v171, v168, v144
    v_fma_f32 v170, -v169, v144, v170
    v_fma_f32 v144, -v169, v148, -v171
    v_mov_b32 v148, v170
    v_cvt_pk_bf16_f32 v88, v148, v144
    v_cvt_pk_bf16_f32 v64, v149, v145
    v_cvt_pk_bf16_f32 v72, v150, v146
    v_cvt_pk_bf16_f32 v80, v151, v147
    v_lshlrev_b32 v140, 16, v88
    v_lshlrev_b32 v141, 16, v64
    v_lshlrev_b32 v142, 16, v72
    v_lshlrev_b32 v143, 16, v80
    v_and_b32 v152, 0xffff0000, v88
    v_and_b32 v153, 0xffff0000, v64
    v_and_b32 v154, 0xffff0000, v72
    v_and_b32 v155, 0xffff0000, v80
    v_sub_f32 v140, v148, v140
    v_sub_f32 v141, v149, v141
    v_sub_f32 v142, v150, v142
    v_sub_f32 v143, v151, v143
    v_sub_f32 v152, v144, v152
    v_sub_f32 v153, v145, v153
    v_sub_f32 v154, v146, v154
    v_sub_f32 v155, v147, v155
    v_cvt_pk_bf16_f32 v92, v140, v152
    v_cvt_pk_bf16_f32 v68, v141, v153
    v_cvt_pk_bf16_f32 v76, v142, v154
    v_cvt_pk_bf16_f32 v84, v143, v155
    v_and_b32 v160, 0xffff0000, v16
    v_and_b32 v161, 0xffff0000, v18
    v_and_b32 v162, 0xffff0000, v20
    v_and_b32 v163, 0xffff0000, v22
    v_and_b32 v164, 0xffff0000, v24
    v_and_b32 v165, 0xffff0000, v26
    v_mul_f32 v166, v9, v160
    v_mul_f32 v167, v9, v161
    v_mul_f32 v162, v9, v162
    v_mul_f32 v163, v9, v163
    v_mul_f32 v166, 0x3fb8aa3b, v166
    v_mul_f32 v167, 0x3e22f983, v167
    v_mul_f32 v168, v164, v162
    v_mul_f32 v169, v164, v163
    v_mul_f32 v140, v166, v5
    v_mul_f32 v141, v166, v6
    v_mul_f32 v142, v166, v7
    v_mul_f32 v143, v166, v8
    v_mul_f32 v144, v167, v5
    v_mul_f32 v145, v167, v6
    v_mul_f32 v146, v167, v7
    v_mul_f32 v147, v167, v8
    v_fma_f32 v168, -v165, v163, v168
    v_fma_f32 v169, v165, v162, v169
    v_exp_f32 v140, v140
    v_exp_f32 v141, v141
    v_exp_f32 v142, v142
    v_exp_f32 v143, v143
    v_fract_f32 v144, v144
    v_fract_f32 v145, v145
    v_fract_f32 v146, v146
    v_fract_f32 v147, v147
    v_cos_f32 v148, v144
    v_cos_f32 v149, v145
    v_cos_f32 v150, v146
    v_cos_f32 v151, v147
    v_sin_f32 v144, v144
    v_sin_f32 v145, v145
    v_sin_f32 v146, v146
    v_sin_f32 v147, v147
    v_mul_f32 v148, v148, v140
    v_mul_f32 v149, v149, v141
    v_mul_f32 v150, v150, v142
    v_mul_f32 v151, v151, v143
    v_mul_f32 v144, v144, v140
    v_mul_f32 v145, v145, v141
    v_mul_f32 v146, v146, v142
    v_mul_f32 v147, v147, v143
    v_mul_f32 v170, v168, v148
    v_mul_f32 v171, v168, v144
    v_fma_f32 v170, -v169, v144, v170
    v_fma_f32 v144, -v169, v148, -v171
    v_mov_b32 v148, v170
    v_cvt_pk_bf16_f32 v89, v148, v144
    v_cvt_pk_bf16_f32 v65, v149, v145
    v_cvt_pk_bf16_f32 v73, v150, v146
    v_cvt_pk_bf16_f32 v81, v151, v147
    v_lshlrev_b32 v140, 16, v89
    v_lshlrev_b32 v141, 16, v65
    v_lshlrev_b32 v142, 16, v73
    v_lshlrev_b32 v143, 16, v81
    v_and_b32 v152, 0xffff0000, v89
    v_and_b32 v153, 0xffff0000, v65
    v_and_b32 v154, 0xffff0000, v73
    v_and_b32 v155, 0xffff0000, v81
    v_sub_f32 v140, v148, v140
    v_sub_f32 v141, v149, v141
    v_sub_f32 v142, v150, v142
    v_sub_f32 v143, v151, v143
    v_sub_f32 v152, v144, v152
    v_sub_f32 v153, v145, v153
    v_sub_f32 v154, v146, v154
    v_sub_f32 v155, v147, v155
    v_cvt_pk_bf16_f32 v93, v140, v152
    v_cvt_pk_bf16_f32 v69, v141, v153
    v_cvt_pk_bf16_f32 v77, v142, v154
    v_cvt_pk_bf16_f32 v85, v143, v155
    v_lshlrev_b32 v160, 16, v17
    v_lshlrev_b32 v161, 16, v19
    v_lshlrev_b32 v162, 16, v21
    v_lshlrev_b32 v163, 16, v23
    v_lshlrev_b32 v164, 16, v25
    v_lshlrev_b32 v165, 16, v27
    v_mul_f32 v166, v9, v160
    v_mul_f32 v167, v9, v161
    v_mul_f32 v162, v9, v162
    v_mul_f32 v163, v9, v163
    v_mul_f32 v166, 0x3fb8aa3b, v166
    v_mul_f32 v167, 0x3e22f983, v167
    v_mul_f32 v168, v164, v162
    v_mul_f32 v169, v164, v163
    v_mul_f32 v140, v166, v5
    v_mul_f32 v141, v166, v6
    v_mul_f32 v142, v166, v7
    v_mul_f32 v143, v166, v8
    v_mul_f32 v144, v167, v5
    v_mul_f32 v145, v167, v6
    v_mul_f32 v146, v167, v7
    v_mul_f32 v147, v167, v8
    v_fma_f32 v168, -v165, v163, v168
    v_fma_f32 v169, v165, v162, v169
    v_exp_f32 v140, v140
    v_exp_f32 v141, v141
    v_exp_f32 v142, v142
    v_exp_f32 v143, v143
    v_fract_f32 v144, v144
    v_fract_f32 v145, v145
    v_fract_f32 v146, v146
    v_fract_f32 v147, v147
    v_cos_f32 v148, v144
    v_cos_f32 v149, v145
    v_cos_f32 v150, v146
    v_cos_f32 v151, v147
    v_sin_f32 v144, v144
    v_sin_f32 v145, v145
    v_sin_f32 v146, v146
    v_sin_f32 v147, v147
    v_mul_f32 v148, v148, v140
    v_mul_f32 v149, v149, v141
    v_mul_f32 v150, v150, v142
    v_mul_f32 v151, v151, v143
    v_mul_f32 v144, v144, v140
    v_mul_f32 v145, v145, v141
    v_mul_f32 v146, v146, v142
    v_mul_f32 v147, v147, v143
    v_mul_f32 v170, v168, v148
    v_mul_f32 v171, v168, v144
    v_fma_f32 v170, -v169, v144, v170
    v_fma_f32 v144, -v169, v148, -v171
    v_mov_b32 v148, v170
    v_cvt_pk_bf16_f32 v90, v148, v144
    v_cvt_pk_bf16_f32 v66, v149, v145
    v_cvt_pk_bf16_f32 v74, v150, v146
    v_cvt_pk_bf16_f32 v82, v151, v147
    v_lshlrev_b32 v140, 16, v90
    v_lshlrev_b32 v141, 16, v66
    v_lshlrev_b32 v142, 16, v74
    v_lshlrev_b32 v143, 16, v82
    v_and_b32 v152, 0xffff0000, v90
    v_and_b32 v153, 0xffff0000, v66
    v_and_b32 v154, 0xffff0000, v74
    v_and_b32 v155, 0xffff0000, v82
    v_sub_f32 v140, v148, v140
    v_sub_f32 v141, v149, v141
    v_sub_f32 v142, v150, v142
    v_sub_f32 v143, v151, v143
    v_sub_f32 v152, v144, v152
    v_sub_f32 v153, v145, v153
    v_sub_f32 v154, v146, v154
    v_sub_f32 v155, v147, v155
    v_cvt_pk_bf16_f32 v94, v140, v152
    v_cvt_pk_bf16_f32 v70, v141, v153
    v_cvt_pk_bf16_f32 v78, v142, v154
    v_cvt_pk_bf16_f32 v86, v143, v155
    v_and_b32 v160, 0xffff0000, v17
    v_and_b32 v161, 0xffff0000, v19
    v_and_b32 v162, 0xffff0000, v21
    v_and_b32 v163, 0xffff0000, v23
    v_and_b32 v164, 0xffff0000, v25
    v_and_b32 v165, 0xffff0000, v27
    v_mul_f32 v166, v9, v160
    v_mul_f32 v167, v9, v161
    v_mul_f32 v162, v9, v162
    v_mul_f32 v163, v9, v163
    v_mul_f32 v166, 0x3fb8aa3b, v166
    v_mul_f32 v167, 0x3e22f983, v167
    v_mul_f32 v168, v164, v162
    v_mul_f32 v169, v164, v163
    v_mul_f32 v140, v166, v5
    v_mul_f32 v141, v166, v6
    v_mul_f32 v142, v166, v7
    v_mul_f32 v143, v166, v8
    v_mul_f32 v144, v167, v5
    v_mul_f32 v145, v167, v6
    v_mul_f32 v146, v167, v7
    v_mul_f32 v147, v167, v8
    v_fma_f32 v168, -v165, v163, v168
    v_fma_f32 v169, v165, v162, v169
    v_exp_f32 v140, v140
    v_exp_f32 v141, v141
    v_exp_f32 v142, v142
    v_exp_f32 v143, v143
    v_fract_f32 v144, v144
    v_fract_f32 v145, v145
    v_fract_f32 v146, v146
    v_fract_f32 v147, v147
    v_cos_f32 v148, v144
    v_cos_f32 v149, v145
    v_cos_f32 v150, v146
    v_cos_f32 v151, v147
    v_sin_f32 v144, v144
    v_sin_f32 v145, v145
    v_sin_f32 v146, v146
    v_sin_f32 v147, v147
    v_mul_f32 v148, v148, v140
    v_mul_f32 v149, v149, v141
    v_mul_f32 v150, v150, v142
    v_mul_f32 v151, v151, v143
    v_mul_f32 v144, v144, v140
    v_mul_f32 v145, v145, v141
    v_mul_f32 v146, v146, v142
    v_mul_f32 v147, v147, v143
    v_mul_f32 v170, v168, v148
    v_mul_f32 v171, v168, v144
    v_fma_f32 v170, -v169, v144, v170
    v_fma_f32 v144, -v169, v148, -v171
    v_mov_b32 v148, v170
    v_cvt_pk_bf16_f32 v91, v148, v144
    v_cvt_pk_bf16_f32 v67, v149, v145
    v_cvt_pk_bf16_f32 v75, v150, v146
    v_cvt_pk_bf16_f32 v83, v151, v147
    v_lshlrev_b32 v140, 16, v91
    v_lshlrev_b32 v141, 16, v67
    v_lshlrev_b32 v142, 16, v75
    v_lshlrev_b32 v143, 16, v83
    v_and_b32 v152, 0xffff0000, v91
    v_and_b32 v153, 0xffff0000, v67
    v_and_b32 v154, 0xffff0000, v75
    v_and_b32 v155, 0xffff0000, v83
    v_sub_f32 v140, v148, v140
    v_sub_f32 v141, v149, v141
    v_sub_f32 v142, v150, v142
    v_sub_f32 v143, v151, v143
    v_sub_f32 v152, v144, v152
    v_sub_f32 v153, v145, v153
    v_sub_f32 v154, v146, v154
    v_sub_f32 v155, v147, v155
    v_cvt_pk_bf16_f32 v95, v140, v152
    v_cvt_pk_bf16_f32 v71, v141, v153
    v_cvt_pk_bf16_f32 v79, v142, v154
    v_cvt_pk_bf16_f32 v87, v143, v155
    v_mfma_f32_16x16x32_bf16 v[128:131], v[68:71], v[88:91], v[128:131]
    v_mfma_f32_16x16x32_bf16 v[128:131], v[64:67], v[92:95], v[128:131]
    v_mfma_f32_16x16x32_bf16 v[128:131], v[64:67], v[88:91], v[128:131]
    v_mfma_f32_16x16x32_bf16 v[132:135], v[76:79], v[88:91], v[132:135]
    v_mfma_f32_16x16x32_bf16 v[132:135], v[72:75], v[92:95], v[132:135]
    v_mfma_f32_16x16x32_bf16 v[132:135], v[72:75], v[88:91], v[132:135]
    v_mfma_f32_16x16x32_bf16 v[136:139], v[84:87], v[88:91], v[136:139]
    v_mfma_f32_16x16x32_bf16 v[136:139], v[80:83], v[92:95], v[136:139]
    v_mfma_f32_16x16x32_bf16 v[136:139], v[80:83], v[88:91], v[136:139]
    s_waitcnt vmcnt(12)
    v_lshlrev_b32 v160, 16, v28
    v_lshlrev_b32 v161, 16, v30
    v_lshlrev_b32 v162, 16, v32
    v_lshlrev_b32 v163, 16, v34
    v_lshlrev_b32 v164, 16, v36
    v_lshlrev_b32 v165, 16, v38
    v_mul_f32 v166, v9, v160
    v_mul_f32 v167, v9, v161
    v_mul_f32 v162, v9, v162
    v_mul_f32 v163, v9, v163
    v_mul_f32 v166, 0x3fb8aa3b, v166
    v_mul_f32 v167, 0x3e22f983, v167
    v_mul_f32 v168, v164, v162
    v_mul_f32 v169, v164, v163
    v_mul_f32 v140, v166, v5
    v_mul_f32 v141, v166, v6
    v_mul_f32 v142, v166, v7
    v_mul_f32 v143, v166, v8
    v_mul_f32 v144, v167, v5
    v_mul_f32 v145, v167, v6
    v_mul_f32 v146, v167, v7
    v_mul_f32 v147, v167, v8
    v_fma_f32 v168, -v165, v163, v168
    v_fma_f32 v169, v165, v162, v169
    v_exp_f32 v140, v140
    v_exp_f32 v141, v141
    v_exp_f32 v142, v142
    v_exp_f32 v143, v143
    v_fract_f32 v144, v144
    v_fract_f32 v145, v145
    v_fract_f32 v146, v146
    v_fract_f32 v147, v147
    v_cos_f32 v148, v144
    v_cos_f32 v149, v145
    v_cos_f32 v150, v146
    v_cos_f32 v151, v147
    v_sin_f32 v144, v144
    v_sin_f32 v145, v145
    v_sin_f32 v146, v146
    v_sin_f32 v147, v147
    v_mul_f32 v148, v148, v140
    v_mul_f32 v149, v149, v141
    v_mul_f32 v150, v150, v142
    v_mul_f32 v151, v151, v143
    v_mul_f32 v144, v144, v140
    v_mul_f32 v145, v145, v141
    v_mul_f32 v146, v146, v142
    v_mul_f32 v147, v147, v143
    v_mul_f32 v170, v168, v148
    v_mul_f32 v171, v168, v144
    v_fma_f32 v170, -v169, v144, v170
    v_fma_f32 v144, -v169, v148, -v171
    v_mov_b32 v148, v170
    v_cvt_pk_bf16_f32 v120, v148, v144
    v_cvt_pk_bf16_f32 v96, v149, v145
    v_cvt_pk_bf16_f32 v104, v150, v146
    v_cvt_pk_bf16_f32 v112, v151, v147
    v_lshlrev_b32 v140, 16, v120
    v_lshlrev_b32 v141, 16, v96
    v_lshlrev_b32 v142, 16, v104
    v_lshlrev_b32 v143, 16, v112
    v_and_b32 v152, 0xffff0000, v120
    v_and_b32 v153, 0xffff0000, v96
    v_and_b32 v154, 0xffff0000, v104
    v_and_b32 v155, 0xffff0000, v112
    v_sub_f32 v140, v148, v140
    v_sub_f32 v141, v149, v141
    v_sub_f32 v142, v150, v142
    v_sub_f32 v143, v151, v143
    v_sub_f32 v152, v144, v152
    v_sub_f32 v153, v145, v153
    v_sub_f32 v154, v146, v154
    v_sub_f32 v155, v147, v155
    v_cvt_pk_bf16_f32 v124, v140, v152
    v_cvt_pk_bf16_f32 v100, v141, v153
    v_cvt_pk_bf16_f32 v108, v142, v154
    v_cvt_pk_bf16_f32 v116, v143, v155
    v_and_b32 v160, 0xffff0000, v28
    v_and_b32 v161, 0xffff0000, v30
    v_and_b32 v162, 0xffff0000, v32
    v_and_b32 v163, 0xffff0000, v34
    v_and_b32 v164, 0xffff0000, v36
    v_and_b32 v165, 0xffff0000, v38
    v_mul_f32 v166, v9, v160
    v_mul_f32 v167, v9, v161
    v_mul_f32 v162, v9, v162
    v_mul_f32 v163, v9, v163
    v_mul_f32 v166, 0x3fb8aa3b, v166
    v_mul_f32 v167, 0x3e22f983, v167
    v_mul_f32 v168, v164, v162
    v_mul_f32 v169, v164, v163
    v_mul_f32 v140, v166, v5
    v_mul_f32 v141, v166, v6
    v_mul_f32 v142, v166, v7
    v_mul_f32 v143, v166, v8
    v_mul_f32 v144, v167, v5
    v_mul_f32 v145, v167, v6
    v_mul_f32 v146, v167, v7
    v_mul_f32 v147, v167, v8
    v_fma_f32 v168, -v165, v163, v168
    v_fma_f32 v169, v165, v162, v169
    v_exp_f32 v140, v140
    v_exp_f32 v141, v141
    v_exp_f32 v142, v142
    v_exp_f32 v143, v143
    v_fract_f32 v144, v144
    v_fract_f32 v145, v145
    v_fract_f32 v146, v146
    v_fract_f32 v147, v147
    v_cos_f32 v148, v144
    v_cos_f32 v149, v145
    v_cos_f32 v150, v146
    v_cos_f32 v151, v147
    v_sin_f32 v144, v144
    v_sin_f32 v145, v145
    v_sin_f32 v146, v146
    v_sin_f32 v147, v147
    v_mul_f32 v148, v148, v140
    v_mul_f32 v149, v149, v141
    v_mul_f32 v150, v150, v142
    v_mul_f32 v151, v151, v143
    v_mul_f32 v144, v144, v140
    v_mul_f32 v145, v145, v141
    v_mul_f32 v146, v146, v142
    v_mul_f32 v147, v147, v143
    v_mul_f32 v170, v168, v148
    v_mul_f32 v171, v168, v144
    v_fma_f32 v170, -v169, v144, v170
    v_fma_f32 v144, -v169, v148, -v171
    v_mov_b32 v148, v170
    v_cvt_pk_bf16_f32 v121, v148, v144
    v_cvt_pk_bf16_f32 v97, v149, v145
    v_cvt_pk_bf16_f32 v105, v150, v146
    v_cvt_pk_bf16_f32 v113, v151, v147
    v_lshlrev_b32 v140, 16, v121
    v_lshlrev_b32 v141, 16, v97
    v_lshlrev_b32 v142, 16, v105
    v_lshlrev_b32 v143, 16, v113
    v_and_b32 v152, 0xffff0000, v121
    v_and_b32 v153, 0xffff0000, v97
    v_and_b32 v154, 0xffff0000, v105
    v_and_b32 v155, 0xffff0000, v113
    v_sub_f32 v140, v148, v140
    v_sub_f32 v141, v149, v141
    v_sub_f32 v142, v150, v142
    v_sub_f32 v143, v151, v143
    v_sub_f32 v152, v144, v152
    v_sub_f32 v153, v145, v153
    v_sub_f32 v154, v146, v154
    v_sub_f32 v155, v147, v155
    v_cvt_pk_bf16_f32 v125, v140, v152
    v_cvt_pk_bf16_f32 v101, v141, v153
    v_cvt_pk_bf16_f32 v109, v142, v154
    v_cvt_pk_bf16_f32 v117, v143, v155
    v_lshlrev_b32 v160, 16, v29
    v_lshlrev_b32 v161, 16, v31
    v_lshlrev_b32 v162, 16, v33
    v_lshlrev_b32 v163, 16, v35
    v_lshlrev_b32 v164, 16, v37
    v_lshlrev_b32 v165, 16, v39
    v_mul_f32 v166, v9, v160
    v_mul_f32 v167, v9, v161
    v_mul_f32 v162, v9, v162
    v_mul_f32 v163, v9, v163
    v_mul_f32 v166, 0x3fb8aa3b, v166
    v_mul_f32 v167, 0x3e22f983, v167
    v_mul_f32 v168, v164, v162
    v_mul_f32 v169, v164, v163
    v_mul_f32 v140, v166, v5
    v_mul_f32 v141, v166, v6
    v_mul_f32 v142, v166, v7
    v_mul_f32 v143, v166, v8
    v_mul_f32 v144, v167, v5
    v_mul_f32 v145, v167, v6
    v_mul_f32 v146, v167, v7
    v_mul_f32 v147, v167, v8
    v_fma_f32 v168, -v165, v163, v168
    v_fma_f32 v169, v165, v162, v169
    v_exp_f32 v140, v140
    v_exp_f32 v141, v141
    v_exp_f32 v142, v142
    v_exp_f32 v143, v143
    v_fract_f32 v144, v144
    v_fract_f32 v145, v145
    v_fract_f32 v146, v146
    v_fract_f32 v147, v147
    v_cos_f32 v148, v144
    v_cos_f32 v149, v145
    v_cos_f32 v150, v146
    v_cos_f32 v151, v147
    v_sin_f32 v144, v144
    v_sin_f32 v145, v145
    v_sin_f32 v146, v146
    v_sin_f32 v147, v147
    v_mul_f32 v148, v148, v140
    v_mul_f32 v149, v149, v141
    v_mul_f32 v150, v150, v142
    v_mul_f32 v151, v151, v143
    v_mul_f32 v144, v144, v140
    v_mul_f32 v145, v145, v141
    v_mul_f32 v146, v146, v142
    v_mul_f32 v147, v147, v143
    v_mul_f32 v170, v168, v148
    v_mul_f32 v171, v168, v144
    v_fma_f32 v170, -v169, v144, v170
    v_fma_f32 v144, -v169, v148, -v171
    v_mov_b32 v148, v170
    v_cvt_pk_bf16_f32 v122, v148, v144
    v_cvt_pk_bf16_f32 v98, v149, v145
    v_cvt_pk_bf16_f32 v106, v150, v146
    v_cvt_pk_bf16_f32 v114, v151, v147
    v_lshlrev_b32 v140, 16, v122
    v_lshlrev_b32 v141, 16, v98
    v_lshlrev_b32 v142, 16, v106
    v_lshlrev_b32 v143, 16, v114
    v_and_b32 v152, 0xffff0000, v122
    v_and_b32 v153, 0xffff0000, v98
    v_and_b32 v154, 0xffff0000, v106
    v_and_b32 v155, 0xffff0000, v114
    v_sub_f32 v140, v148, v140
    v_sub_f32 v141, v149, v141
    v_sub_f32 v142, v150, v142
    v_sub_f32 v143, v151, v143
    v_sub_f32 v152, v144, v152
    v_sub_f32 v153, v145, v153
    v_sub_f32 v154, v146, v154
    v_sub_f32 v155, v147, v155
    v_cvt_pk_bf16_f32 v126, v140, v152
    v_cvt_pk_bf16_f32 v102, v141, v153
    v_cvt_pk_bf16_f32 v110, v142, v154
    v_cvt_pk_bf16_f32 v118, v143, v155
    v_and_b32 v160, 0xffff0000, v29
    v_and_b32 v161, 0xffff0000, v31
    v_and_b32 v162, 0xffff0000, v33
    v_and_b32 v163, 0xffff0000, v35
    v_and_b32 v164, 0xffff0000, v37
    v_and_b32 v165, 0xffff0000, v39
    v_mul_f32 v166, v9, v160
    v_mul_f32 v167, v9, v161
    v_mul_f32 v162, v9, v162
    v_mul_f32 v163, v9, v163
    v_mul_f32 v166, 0x3fb8aa3b, v166
    v_mul_f32 v167, 0x3e22f983, v167
    v_mul_f32 v168, v164, v162
    v_mul_f32 v169, v164, v163
    v_mul_f32 v140, v166, v5
    v_mul_f32 v141, v166, v6
    v_mul_f32 v142, v166, v7
    v_mul_f32 v143, v166, v8
    v_mul_f32 v144, v167, v5
    v_mul_f32 v145, v167, v6
    v_mul_f32 v146, v167, v7
    v_mul_f32 v147, v167, v8
    v_fma_f32 v168, -v165, v163, v168
    v_fma_f32 v169, v165, v162, v169
    v_exp_f32 v140, v140
    v_exp_f32 v141, v141
    v_exp_f32 v142, v142
    v_exp_f32 v143, v143
    v_fract_f32 v144, v144
    v_fract_f32 v145, v145
    v_fract_f32 v146, v146
    v_fract_f32 v147, v147
    v_cos_f32 v148, v144
    v_cos_f32 v149, v145
    v_cos_f32 v150, v146
    v_cos_f32 v151, v147
    v_sin_f32 v144, v144
    v_sin_f32 v145, v145
    v_sin_f32 v146, v146
    v_sin_f32 v147, v147
    v_mul_f32 v148, v148, v140
    v_mul_f32 v149, v149, v141
    v_mul_f32 v150, v150, v142
    v_mul_f32 v151, v151, v143
    v_mul_f32 v144, v144, v140
    v_mul_f32 v145, v145, v141
    v_mul_f32 v146, v146, v142
    v_mul_f32 v147, v147, v143
    v_mul_f32 v170, v168, v148
    v_mul_f32 v171, v168, v144
    v_fma_f32 v170, -v169, v144, v170
    v_fma_f32 v144, -v169, v148, -v171
    v_mov_b32 v148, v170
    v_cvt_pk_bf16_f32 v123, v148, v144
    v_cvt_pk_bf16_f32 v99, v149, v145
    v_cvt_pk_bf16_f32 v107, v150, v146
    v_cvt_pk_bf16_f32 v115, v151, v147
    v_lshlrev_b32 v140, 16, v123
    v_lshlrev_b32 v141, 16, v99
    v_lshlrev_b32 v142, 16, v107
    v_lshlrev_b32 v143, 16, v115
    v_and_b32 v152, 0xffff0000, v123
    v_and_b32 v153, 0xffff0000, v99
    v_and_b32 v154, 0xffff0000, v107
    v_and_b32 v155, 0xffff0000, v115
    v_sub_f32 v140, v148, v140
    v_sub_f32 v141, v149, v141
    v_sub_f32 v142, v150, v142
    v_sub_f32 v143, v151, v143
    v_sub_f32 v152, v144, v152
    v_sub_f32 v153, v145, v153
    v_sub_f32 v154, v146, v154
    v_sub_f32 v155, v147, v155
    v_cvt_pk_bf16_f32 v127, v140, v152
    v_cvt_pk_bf16_f32 v103, v141, v153
    v_cvt_pk_bf16_f32 v111, v142, v154
    v_cvt_pk_bf16_f32 v119, v143, v155
    v_mfma_f32_16x16x32_bf16 v[128:131], v[100:103], v[120:123], v[128:131]
    v_mfma_f32_16x16x32_bf16 v[128:131], v[96:99], v[124:127], v[128:131]
    v_mfma_f32_16x16x32_bf16 v[128:131], v[96:99], v[120:123], v[128:131]
    v_mfma_f32_16x16x32_bf16 v[132:135], v[108:111], v[120:123], v[132:135]
    v_mfma_f32_16x16x32_bf16 v[132:135], v[104:107], v[124:127], v[132:135]
    v_mfma_f32_16x16x32_bf16 v[132:135], v[104:107], v[120:123], v[132:135]
    v_mfma_f32_16x16x32_bf16 v[136:139], v[116:119], v[120:123], v[136:139]
    v_mfma_f32_16x16x32_bf16 v[136:139], v[112:115], v[124:127], v[136:139]
    v_mfma_f32_16x16x32_bf16 v[136:139], v[112:115], v[120:123], v[136:139]
    s_waitcnt vmcnt(6)
    v_lshlrev_b32 v160, 16, v40
    v_lshlrev_b32 v161, 16, v42
    v_lshlrev_b32 v162, 16, v44
    v_lshlrev_b32 v163, 16, v46
    v_lshlrev_b32 v164, 16, v48
    v_lshlrev_b32 v165, 16, v50
    v_mul_f32 v166, v9, v160
    v_mul_f32 v167, v9, v161
    v_mul_f32 v162, v9, v162
    v_mul_f32 v163, v9, v163
    v_mul_f32 v166, 0x3fb8aa3b, v166
    v_mul_f32 v167, 0x3e22f983, v167
    v_mul_f32 v168, v164, v162
    v_mul_f32 v169, v164, v163
    v_mul_f32 v140, v166, v5
    v_mul_f32 v141, v166, v6
    v_mul_f32 v142, v166, v7
    v_mul_f32 v143, v166, v8
    v_mul_f32 v144, v167, v5
    v_mul_f32 v145, v167, v6
    v_mul_f32 v146, v167, v7
    v_mul_f32 v147, v167, v8
    v_fma_f32 v168, -v165, v163, v168
    v_fma_f32 v169, v165, v162, v169
    v_exp_f32 v140, v140
    v_exp_f32 v141, v141
    v_exp_f32 v142, v142
    v_exp_f32 v143, v143
    v_fract_f32 v144, v144
    v_fract_f32 v145, v145
    v_fract_f32 v146, v146
    v_fract_f32 v147, v147
    v_cos_f32 v148, v144
    v_cos_f32 v149, v145
    v_cos_f32 v150, v146
    v_cos_f32 v151, v147
    v_sin_f32 v144, v144
    v_sin_f32 v145, v145
    v_sin_f32 v146, v146
    v_sin_f32 v147, v147
    v_mul_f32 v148, v148, v140
    v_mul_f32 v149, v149, v141
    v_mul_f32 v150, v150, v142
    v_mul_f32 v151, v151, v143
    v_mul_f32 v144, v144, v140
    v_mul_f32 v145, v145, v141
    v_mul_f32 v146, v146, v142
    v_mul_f32 v147, v147, v143
    v_mul_f32 v170, v168, v148
    v_mul_f32 v171, v168, v144
    v_fma_f32 v170, -v169, v144, v170
    v_fma_f32 v144, -v169, v148, -v171
    v_mov_b32 v148, v170
    v_cvt_pk_bf16_f32 v88, v148, v144
    v_cvt_pk_bf16_f32 v64, v149, v145
    v_cvt_pk_bf16_f32 v72, v150, v146
    v_cvt_pk_bf16_f32 v80, v151, v147
    v_lshlrev_b32 v140, 16, v88
    v_lshlrev_b32 v141, 16, v64
    v_lshlrev_b32 v142, 16, v72
    v_lshlrev_b32 v143, 16, v80
    v_and_b32 v152, 0xffff0000, v88
    v_and_b32 v153, 0xffff0000, v64
    v_and_b32 v154, 0xffff0000, v72
    v_and_b32 v155, 0xffff0000, v80
    v_sub_f32 v140, v148, v140
    v_sub_f32 v141, v149, v141
    v_sub_f32 v142, v150, v142
    v_sub_f32 v143, v151, v143
    v_sub_f32 v152, v144, v152
    v_sub_f32 v153, v145, v153
    v_sub_f32 v154, v146, v154
    v_sub_f32 v155, v147, v155
    v_cvt_pk_bf16_f32 v92, v140, v152
    v_cvt_pk_bf16_f32 v68, v141, v153
    v_cvt_pk_bf16_f32 v76, v142, v154
    v_cvt_pk_bf16_f32 v84, v143, v155
    v_and_b32 v160, 0xffff0000, v40
    v_and_b32 v161, 0xffff0000, v42
    v_and_b32 v162, 0xffff0000, v44
    v_and_b32 v163, 0xffff0000, v46
    v_and_b32 v164, 0xffff0000, v48
    v_and_b32 v165, 0xffff0000, v50
    v_mul_f32 v166, v9, v160
    v_mul_f32 v167, v9, v161
    v_mul_f32 v162, v9, v162
    v_mul_f32 v163, v9, v163
    v_mul_f32 v166, 0x3fb8aa3b, v166
    v_mul_f32 v167, 0x3e22f983, v167
    v_mul_f32 v168, v164, v162
    v_mul_f32 v169, v164, v163
    v_mul_f32 v140, v166, v5
    v_mul_f32 v141, v166, v6
    v_mul_f32 v142, v166, v7
    v_mul_f32 v143, v166, v8
    v_mul_f32 v144, v167, v5
    v_mul_f32 v145, v167, v6
    v_mul_f32 v146, v167, v7
    v_mul_f32 v147, v167, v8
    v_fma_f32 v168, -v165, v163, v168
    v_fma_f32 v169, v165, v162, v169
    v_exp_f32 v140, v140
    v_exp_f32 v141, v141
    v_exp_f32 v142, v142
    v_exp_f32 v143, v143
    v_fract_f32 v144, v144
    v_fract_f32 v145, v145
    v_fract_f32 v146, v146
    v_fract_f32 v147, v147
    v_cos_f32 v148, v144
    v_cos_f32 v149, v145
    v_cos_f32 v150, v146
    v_cos_f32 v151, v147
    v_sin_f32 v144, v144
    v_sin_f32 v145, v145
    v_sin_f32 v146, v146
    v_sin_f32 v147, v147
    v_mul_f32 v148, v148, v140
    v_mul_f32 v149, v149, v141
    v_mul_f32 v150, v150, v142
    v_mul_f32 v151, v151, v143
    v_mul_f32 v144, v144, v140
    v_mul_f32 v145, v145, v141
    v_mul_f32 v146, v146, v142
    v_mul_f32 v147, v147, v143
    v_mul_f32 v170, v168, v148
    v_mul_f32 v171, v168, v144
    v_fma_f32 v170, -v169, v144, v170
    v_fma_f32 v144, -v169, v148, -v171
    v_mov_b32 v148, v170
    v_cvt_pk_bf16_f32 v89, v148, v144
    v_cvt_pk_bf16_f32 v65, v149, v145
    v_cvt_pk_bf16_f32 v73, v150, v146
    v_cvt_pk_bf16_f32 v81, v151, v147
    v_lshlrev_b32 v140, 16, v89
    v_lshlrev_b32 v141, 16, v65
    v_lshlrev_b32 v142, 16, v73
    v_lshlrev_b32 v143, 16, v81
    v_and_b32 v152, 0xffff0000, v89
    v_and_b32 v153, 0xffff0000, v65
    v_and_b32 v154, 0xffff0000, v73
    v_and_b32 v155, 0xffff0000, v81
    v_sub_f32 v140, v148, v140
    v_sub_f32 v141, v149, v141
    v_sub_f32 v142, v150, v142
    v_sub_f32 v143, v151, v143
    v_sub_f32 v152, v144, v152
    v_sub_f32 v153, v145, v153
    v_sub_f32 v154, v146, v154
    v_sub_f32 v155, v147, v155
    v_cvt_pk_bf16_f32 v93, v140, v152
    v_cvt_pk_bf16_f32 v69, v141, v153
    v_cvt_pk_bf16_f32 v77, v142, v154
    v_cvt_pk_bf16_f32 v85, v143, v155
    v_lshlrev_b32 v160, 16, v41
    v_lshlrev_b32 v161, 16, v43
    v_lshlrev_b32 v162, 16, v45
    v_lshlrev_b32 v163, 16, v47
    v_lshlrev_b32 v164, 16, v49
    v_lshlrev_b32 v165, 16, v51
    v_mul_f32 v166, v9, v160
    v_mul_f32 v167, v9, v161
    v_mul_f32 v162, v9, v162
    v_mul_f32 v163, v9, v163
    v_mul_f32 v166, 0x3fb8aa3b, v166
    v_mul_f32 v167, 0x3e22f983, v167
    v_mul_f32 v168, v164, v162
    v_mul_f32 v169, v164, v163
    v_mul_f32 v140, v166, v5
    v_mul_f32 v141, v166, v6
    v_mul_f32 v142, v166, v7
    v_mul_f32 v143, v166, v8
    v_mul_f32 v144, v167, v5
    v_mul_f32 v145, v167, v6
    v_mul_f32 v146, v167, v7
    v_mul_f32 v147, v167, v8
    v_fma_f32 v168, -v165, v163, v168
    v_fma_f32 v169, v165, v162, v169
    v_exp_f32 v140, v140
    v_exp_f32 v141, v141
    v_exp_f32 v142, v142
    v_exp_f32 v143, v143
    v_fract_f32 v144, v144
    v_fract_f32 v145, v145
    v_fract_f32 v146, v146
    v_fract_f32 v147, v147
    v_cos_f32 v148, v144
    v_cos_f32 v149, v145
    v_cos_f32 v150, v146
    v_cos_f32 v151, v147
    v_sin_f32 v144, v144
    v_sin_f32 v145, v145
    v_sin_f32 v146, v146
    v_sin_f32 v147, v147
    v_mul_f32 v148, v148, v140
    v_mul_f32 v149, v149, v141
    v_mul_f32 v150, v150, v142
    v_mul_f32 v151, v151, v143
    v_mul_f32 v144, v144, v140
    v_mul_f32 v145, v145, v141
    v_mul_f32 v146, v146, v142
    v_mul_f32 v147, v147, v143
    v_mul_f32 v170, v168, v148
    v_mul_f32 v171, v168, v144
    v_fma_f32 v170, -v169, v144, v170
    v_fma_f32 v144, -v169, v148, -v171
    v_mov_b32 v148, v170
    v_cvt_pk_bf16_f32 v90, v148, v144
    v_cvt_pk_bf16_f32 v66, v149, v145
    v_cvt_pk_bf16_f32 v74, v150, v146
    v_cvt_pk_bf16_f32 v82, v151, v147
    v_lshlrev_b32 v140, 16, v90
    v_lshlrev_b32 v141, 16, v66
    v_lshlrev_b32 v142, 16, v74
    v_lshlrev_b32 v143, 16, v82
    v_and_b32 v152, 0xffff0000, v90
    v_and_b32 v153, 0xffff0000, v66
    v_and_b32 v154, 0xffff0000, v74
    v_and_b32 v155, 0xffff0000, v82
    v_sub_f32 v140, v148, v140
    v_sub_f32 v141, v149, v141
    v_sub_f32 v142, v150, v142
    v_sub_f32 v143, v151, v143
    v_sub_f32 v152, v144, v152
    v_sub_f32 v153, v145, v153
    v_sub_f32 v154, v146, v154
    v_sub_f32 v155, v147, v155
    v_cvt_pk_bf16_f32 v94, v140, v152
    v_cvt_pk_bf16_f32 v70, v141, v153
    v_cvt_pk_bf16_f32 v78, v142, v154
    v_cvt_pk_bf16_f32 v86, v143, v155
    v_and_b32 v160, 0xffff0000, v41
    v_and_b32 v161, 0xffff0000, v43
    v_and_b32 v162, 0xffff0000, v45
    v_and_b32 v163, 0xffff0000, v47
    v_and_b32 v164, 0xffff0000, v49
    v_and_b32 v165, 0xffff0000, v51
    v_mul_f32 v166, v9, v160
    v_mul_f32 v167, v9, v161
    v_mul_f32 v162, v9, v162
    v_mul_f32 v163, v9, v163
    v_mul_f32 v166, 0x3fb8aa3b, v166
    v_mul_f32 v167, 0x3e22f983, v167
    v_mul_f32 v168, v164, v162
    v_mul_f32 v169, v164, v163
    v_mul_f32 v140, v166, v5
    v_mul_f32 v141, v166, v6
    v_mul_f32 v142, v166, v7
    v_mul_f32 v143, v166, v8
    v_mul_f32 v144, v167, v5
    v_mul_f32 v145, v167, v6
    v_mul_f32 v146, v167, v7
    v_mul_f32 v147, v167, v8
    v_fma_f32 v168, -v165, v163, v168
    v_fma_f32 v169, v165, v162, v169
    v_exp_f32 v140, v140
    v_exp_f32 v141, v141
    v_exp_f32 v142, v142
    v_exp_f32 v143, v143
    v_fract_f32 v144, v144
    v_fract_f32 v145, v145
    v_fract_f32 v146, v146
    v_fract_f32 v147, v147
    v_cos_f32 v148, v144
    v_cos_f32 v149, v145
    v_cos_f32 v150, v146
    v_cos_f32 v151, v147
    v_sin_f32 v144, v144
    v_sin_f32 v145, v145
    v_sin_f32 v146, v146
    v_sin_f32 v147, v147
    v_mul_f32 v148, v148, v140
    v_mul_f32 v149, v149, v141
    v_mul_f32 v150, v150, v142
    v_mul_f32 v151, v151, v143
    v_mul_f32 v144, v144, v140
    v_mul_f32 v145, v145, v141
    v_mul_f32 v146, v146, v142
    v_mul_f32 v147, v147, v143
    v_mul_f32 v170, v168, v148
    v_mul_f32 v171, v168, v144
    v_fma_f32 v170, -v169, v144, v170
    v_fma_f32 v144, -v169, v148, -v171
    v_mov_b32 v148, v170
    v_cvt_pk_bf16_f32 v91, v148, v144
    v_cvt_pk_bf16_f32 v67, v149, v145
    v_cvt_pk_bf16_f32 v75, v150, v146
    v_cvt_pk_bf16_f32 v83, v151, v147
    v_lshlrev_b32 v140, 16, v91
    v_lshlrev_b32 v141, 16, v67
    v_lshlrev_b32 v142, 16, v75
    v_lshlrev_b32 v143, 16, v83
    v_and_b32 v152, 0xffff0000, v91
    v_and_b32 v153, 0xffff0000, v67
    v_and_b32 v154, 0xffff0000, v75
    v_and_b32 v155, 0xffff0000, v83
    v_sub_f32 v140, v148, v140
    v_sub_f32 v141, v149, v141
    v_sub_f32 v142, v150, v142
    v_sub_f32 v143, v151, v143
    v_sub_f32 v152, v144, v152
    v_sub_f32 v153, v145, v153
    v_sub_f32 v154, v146, v154
    v_sub_f32 v155, v147, v155
    v_cvt_pk_bf16_f32 v95, v140, v152
    v_cvt_pk_bf16_f32 v71, v141, v153
    v_cvt_pk_bf16_f32 v79, v142, v154
    v_cvt_pk_bf16_f32 v87, v143, v155
    v_mfma_f32_16x16x32_bf16 v[128:131], v[68:71], v[88:91], v[128:131]
    v_mfma_f32_16x16x32_bf16 v[128:131], v[64:67], v[92:95], v[128:131]
    v_mfma_f32_16x16x32_bf16 v[128:131], v[64:67], v[88:91], v[128:131]
    v_mfma_f32_16x16x32_bf16 v[132:135], v[76:79], v[88:91], v[132:135]
    v_mfma_f32_16x16x32_bf16 v[132:135], v[72:75], v[92:95], v[132:135]
    v_mfma_f32_16x16x32_bf16 v[132:135], v[72:75], v[88:91], v[132:135]
    v_mfma_f32_16x16x32_bf16 v[136:139], v[84:87], v[88:91], v[136:139]
    v_mfma_f32_16x16x32_bf16 v[136:139], v[80:83], v[92:95], v[136:139]
    v_mfma_f32_16x16x32_bf16 v[136:139], v[80:83], v[88:91], v[136:139]
    s_waitcnt vmcnt(0)
    v_lshlrev_b32 v160, 16, v52
    v_lshlrev_b32 v161, 16, v54
    v_lshlrev_b32 v162, 16, v56
    v_lshlrev_b32 v163, 16, v58
    v_lshlrev_b32 v164, 16, v60
    v_lshlrev_b32 v165, 16, v62
    v_mul_f32 v166, v9, v160
    v_mul_f32 v167, v9, v161
    v_mul_f32 v162, v9, v162
    v_mul_f32 v163, v9, v163
    v_mul_f32 v166, 0x3fb8aa3b, v166
    v_mul_f32 v167, 0x3e22f983, v167
    v_mul_f32 v168, v164, v162
    v_mul_f32 v169, v164, v163
    v_mul_f32 v140, v166, v5
    v_mul_f32 v141, v166, v6
    v_mul_f32 v142, v166, v7
    v_mul_f32 v143, v166, v8
    v_mul_f32 v144, v167, v5
    v_mul_f32 v145, v167, v6
    v_mul_f32 v146, v167, v7
    v_mul_f32 v147, v167, v8
    v_fma_f32 v168, -v165, v163, v168
    v_fma_f32 v169, v165, v162, v169
    v_exp_f32 v140, v140
    v_exp_f32 v141, v141
    v_exp_f32 v142, v142
    v_exp_f32 v143, v143
    v_fract_f32 v144, v144
    v_fract_f32 v145, v145
    v_fract_f32 v146, v146
    v_fract_f32 v147, v147
    v_cos_f32 v148, v144
    v_cos_f32 v149, v145
    v_cos_f32 v150, v146
    v_cos_f32 v151, v147
    v_sin_f32 v144, v144
    v_sin_f32 v145, v145
    v_sin_f32 v146, v146
    v_sin_f32 v147, v147
    v_mul_f32 v148, v148, v140
    v_mul_f32 v149, v149, v141
    v_mul_f32 v150, v150, v142
    v_mul_f32 v151, v151, v143
    v_mul_f32 v144, v144, v140
    v_mul_f32 v145, v145, v141
    v_mul_f32 v146, v146, v142
    v_mul_f32 v147, v147, v143
    v_mul_f32 v170, v168, v148
    v_mul_f32 v171, v168, v144
    v_fma_f32 v170, -v169, v144, v170
    v_fma_f32 v144, -v169, v148, -v171
    v_mov_b32 v148, v170
    v_cvt_pk_bf16_f32 v120, v148, v144
    v_cvt_pk_bf16_f32 v96, v149, v145
    v_cvt_pk_bf16_f32 v104, v150, v146
    v_cvt_pk_bf16_f32 v112, v151, v147
    v_lshlrev_b32 v140, 16, v120
    v_lshlrev_b32 v141, 16, v96
    v_lshlrev_b32 v142, 16, v104
    v_lshlrev_b32 v143, 16, v112
    v_and_b32 v152, 0xffff0000, v120
    v_and_b32 v153, 0xffff0000, v96
    v_and_b32 v154, 0xffff0000, v104
    v_and_b32 v155, 0xffff0000, v112
    v_sub_f32 v140, v148, v140
    v_sub_f32 v141, v149, v141
    v_sub_f32 v142, v150, v142
    v_sub_f32 v143, v151, v143
    v_sub_f32 v152, v144, v152
    v_sub_f32 v153, v145, v153
    v_sub_f32 v154, v146, v154
    v_sub_f32 v155, v147, v155
    v_cvt_pk_bf16_f32 v124, v140, v152
    v_cvt_pk_bf16_f32 v100, v141, v153
    v_cvt_pk_bf16_f32 v108, v142, v154
    v_cvt_pk_bf16_f32 v116, v143, v155
    v_and_b32 v160, 0xffff0000, v52
    v_and_b32 v161, 0xffff0000, v54
    v_and_b32 v162, 0xffff0000, v56
    v_and_b32 v163, 0xffff0000, v58
    v_and_b32 v164, 0xffff0000, v60
    v_and_b32 v165, 0xffff0000, v62
    v_mul_f32 v166, v9, v160
    v_mul_f32 v167, v9, v161
    v_mul_f32 v162, v9, v162
    v_mul_f32 v163, v9, v163
    v_mul_f32 v166, 0x3fb8aa3b, v166
    v_mul_f32 v167, 0x3e22f983, v167
    v_mul_f32 v168, v164, v162
    v_mul_f32 v169, v164, v163
    v_mul_f32 v140, v166, v5
    v_mul_f32 v141, v166, v6
    v_mul_f32 v142, v166, v7
    v_mul_f32 v143, v166, v8
    v_mul_f32 v144, v167, v5
    v_mul_f32 v145, v167, v6
    v_mul_f32 v146, v167, v7
    v_mul_f32 v147, v167, v8
    v_fma_f32 v168, -v165, v163, v168
    v_fma_f32 v169, v165, v162, v169
    v_exp_f32 v140, v140
    v_exp_f32 v141, v141
    v_exp_f32 v142, v142
    v_exp_f32 v143, v143
    v_fract_f32 v144, v144
    v_fract_f32 v145, v145
    v_fract_f32 v146, v146
    v_fract_f32 v147, v147
    v_cos_f32 v148, v144
    v_cos_f32 v149, v145
    v_cos_f32 v150, v146
    v_cos_f32 v151, v147
    v_sin_f32 v144, v144
    v_sin_f32 v145, v145
    v_sin_f32 v146, v146
    v_sin_f32 v147, v147
    v_mul_f32 v148, v148, v140
    v_mul_f32 v149, v149, v141
    v_mul_f32 v150, v150, v142
    v_mul_f32 v151, v151, v143
    v_mul_f32 v144, v144, v140
    v_mul_f32 v145, v145, v141
    v_mul_f32 v146, v146, v142
    v_mul_f32 v147, v147, v143
    v_mul_f32 v170, v168, v148
    v_mul_f32 v171, v168, v144
    v_fma_f32 v170, -v169, v144, v170
    v_fma_f32 v144, -v169, v148, -v171
    v_mov_b32 v148, v170
    v_cvt_pk_bf16_f32 v121, v148, v144
    v_cvt_pk_bf16_f32 v97, v149, v145
    v_cvt_pk_bf16_f32 v105, v150, v146
    v_cvt_pk_bf16_f32 v113, v151, v147
    v_lshlrev_b32 v140, 16, v121
    v_lshlrev_b32 v141, 16, v97
    v_lshlrev_b32 v142, 16, v105
    v_lshlrev_b32 v143, 16, v113
    v_and_b32 v152, 0xffff0000, v121
    v_and_b32 v153, 0xffff0000, v97
    v_and_b32 v154, 0xffff0000, v105
    v_and_b32 v155, 0xffff0000, v113
    v_sub_f32 v140, v148, v140
    v_sub_f32 v141, v149, v141
    v_sub_f32 v142, v150, v142
    v_sub_f32 v143, v151, v143
    v_sub_f32 v152, v144, v152
    v_sub_f32 v153, v145, v153
    v_sub_f32 v154, v146, v154
    v_sub_f32 v155, v147, v155
    v_cvt_pk_bf16_f32 v125, v140, v152
    v_cvt_pk_bf16_f32 v101, v141, v153
    v_cvt_pk_bf16_f32 v109, v142, v154
    v_cvt_pk_bf16_f32 v117, v143, v155
    v_lshlrev_b32 v160, 16, v53
    v_lshlrev_b32 v161, 16, v55
    v_lshlrev_b32 v162, 16, v57
    v_lshlrev_b32 v163, 16, v59
    v_lshlrev_b32 v164, 16, v61
    v_lshlrev_b32 v165, 16, v63
    v_mul_f32 v166, v9, v160
    v_mul_f32 v167, v9, v161
    v_mul_f32 v162, v9, v162
    v_mul_f32 v163, v9, v163
    v_mul_f32 v166, 0x3fb8aa3b, v166
    v_mul_f32 v167, 0x3e22f983, v167
    v_mul_f32 v168, v164, v162
    v_mul_f32 v169, v164, v163
    v_mul_f32 v140, v166, v5
    v_mul_f32 v141, v166, v6
    v_mul_f32 v142, v166, v7
    v_mul_f32 v143, v166, v8
    v_mul_f32 v144, v167, v5
    v_mul_f32 v145, v167, v6
    v_mul_f32 v146, v167, v7
    v_mul_f32 v147, v167, v8
    v_fma_f32 v168, -v165, v163, v168
    v_fma_f32 v169, v165, v162, v169
    v_exp_f32 v140, v140
    v_exp_f32 v141, v141
    v_exp_f32 v142, v142
    v_exp_f32 v143, v143
    v_fract_f32 v144, v144
    v_fract_f32 v145, v145
    v_fract_f32 v146, v146
    v_fract_f32 v147, v147
    v_cos_f32 v148, v144
    v_cos_f32 v149, v145
    v_cos_f32 v150, v146
    v_cos_f32 v151, v147
    v_sin_f32 v144, v144
    v_sin_f32 v145, v145
    v_sin_f32 v146, v146
    v_sin_f32 v147, v147
    v_mul_f32 v148, v148, v140
    v_mul_f32 v149, v149, v141
    v_mul_f32 v150, v150, v142
    v_mul_f32 v151, v151, v143
    v_mul_f32 v144, v144, v140
    v_mul_f32 v145, v145, v141
    v_mul_f32 v146, v146, v142
    v_mul_f32 v147, v147, v143
    v_mul_f32 v170, v168, v148
    v_mul_f32 v171, v168, v144
    v_fma_f32 v170, -v169, v144, v170
    v_fma_f32 v144, -v169, v148, -v171
    v_mov_b32 v148, v170
    v_cvt_pk_bf16_f32 v122, v148, v144
    v_cvt_pk_bf16_f32 v98, v149, v145
    v_cvt_pk_bf16_f32 v106, v150, v146
    v_cvt_pk_bf16_f32 v114, v151, v147
    v_lshlrev_b32 v140, 16, v122
    v_lshlrev_b32 v141, 16, v98
    v_lshlrev_b32 v142, 16, v106
    v_lshlrev_b32 v143, 16, v114
    v_and_b32 v152, 0xffff0000, v122
    v_and_b32 v153, 0xffff0000, v98
    v_and_b32 v154, 0xffff0000, v106
    v_and_b32 v155, 0xffff0000, v114
    v_sub_f32 v140, v148, v140
    v_sub_f32 v141, v149, v141
    v_sub_f32 v142, v150, v142
    v_sub_f32 v143, v151, v143
    v_sub_f32 v152, v144, v152
    v_sub_f32 v153, v145, v153
    v_sub_f32 v154, v146, v154
    v_sub_f32 v155, v147, v155
    v_cvt_pk_bf16_f32 v126, v140, v152
    v_cvt_pk_bf16_f32 v102, v141, v153
    v_cvt_pk_bf16_f32 v110, v142, v154
    v_cvt_pk_bf16_f32 v118, v143, v155
    v_and_b32 v160, 0xffff0000, v53
    v_and_b32 v161, 0xffff0000, v55
    v_and_b32 v162, 0xffff0000, v57
    v_and_b32 v163, 0xffff0000, v59
    v_and_b32 v164, 0xffff0000, v61
    v_and_b32 v165, 0xffff0000, v63
    v_mul_f32 v166, v9, v160
    v_mul_f32 v167, v9, v161
    v_mul_f32 v162, v9, v162
    v_mul_f32 v163, v9, v163
    v_mul_f32 v166, 0x3fb8aa3b, v166
    v_mul_f32 v167, 0x3e22f983, v167
    v_mul_f32 v168, v164, v162
    v_mul_f32 v169, v164, v163
    v_mul_f32 v140, v166, v5
    v_mul_f32 v141, v166, v6
    v_mul_f32 v142, v166, v7
    v_mul_f32 v143, v166, v8
    v_mul_f32 v144, v167, v5
    v_mul_f32 v145, v167, v6
    v_mul_f32 v146, v167, v7
    v_mul_f32 v147, v167, v8
    v_fma_f32 v168, -v165, v163, v168
    v_fma_f32 v169, v165, v162, v169
    v_exp_f32 v140, v140
    v_exp_f32 v141, v141
    v_exp_f32 v142, v142
    v_exp_f32 v143, v143
    v_fract_f32 v144, v144
    v_fract_f32 v145, v145
    v_fract_f32 v146, v146
    v_fract_f32 v147, v147
    v_cos_f32 v148, v144
    v_cos_f32 v149, v145
    v_cos_f32 v150, v146
    v_cos_f32 v151, v147
    v_sin_f32 v144, v144
    v_sin_f32 v145, v145
    v_sin_f32 v146, v146
    v_sin_f32 v147, v147
    v_mul_f32 v148, v148, v140
    v_mul_f32 v149, v149, v141
    v_mul_f32 v150, v150, v142
    v_mul_f32 v151, v151, v143
    v_mul_f32 v144, v144, v140
    v_mul_f32 v145, v145, v141
    v_mul_f32 v146, v146, v142
    v_mul_f32 v147, v147, v143
    v_mul_f32 v170, v168, v148
    v_mul_f32 v171, v168, v144
    v_fma_f32 v170, -v169, v144, v170
    v_fma_f32 v144, -v169, v148, -v171
    v_mov_b32 v148, v170
    v_cvt_pk_bf16_f32 v123, v148, v144
    v_cvt_pk_bf16_f32 v99, v149, v145
    v_cvt_pk_bf16_f32 v107, v150, v146
    v_cvt_pk_bf16_f32 v115, v151, v147
    v_lshlrev_b32 v140, 16, v123
    v_lshlrev_b32 v141, 16, v99
    v_lshlrev_b32 v142, 16, v107
    v_lshlrev_b32 v143, 16, v115
    v_and_b32 v152, 0xffff0000, v123
    v_and_b32 v153, 0xffff0000, v99
    v_and_b32 v154, 0xffff0000, v107
    v_and_b32 v155, 0xffff0000, v115
    v_sub_f32 v140, v148, v140
    v_sub_f32 v141, v149, v141
    v_sub_f32 v142, v150, v142
    v_sub_f32 v143, v151, v143
    v_sub_f32 v152, v144, v152
    v_sub_f32 v153, v145, v153
    v_sub_f32 v154, v146, v154
    v_sub_f32 v155, v147, v155
    v_cvt_pk_bf16_f32 v127, v140, v152
    v_cvt_pk_bf16_f32 v103, v141, v153
    v_cvt_pk_bf16_f32 v111, v142, v154
    v_cvt_pk_bf16_f32 v119, v143, v155
    v_mfma_f32_16x16x32_bf16 v[128:131], v[100:103], v[120:123], v[128:131]
    v_mfma_f32_16x16x32_bf16 v[128:131], v[96:99], v[124:127], v[128:131]
    v_mfma_f32_16x16x32_bf16 v[128:131], v[96:99], v[120:123], v[128:131]
    v_mfma_f32_16x16x32_bf16 v[132:135], v[108:111], v[120:123], v[132:135]
    v_mfma_f32_16x16x32_bf16 v[132:135], v[104:107], v[124:127], v[132:135]
    v_mfma_f32_16x16x32_bf16 v[132:135], v[104:107], v[120:123], v[132:135]
    v_mfma_f32_16x16x32_bf16 v[136:139], v[116:119], v[120:123], v[136:139]
    v_mfma_f32_16x16x32_bf16 v[136:139], v[112:115], v[124:127], v[136:139]
    v_mfma_f32_16x16x32_bf16 v[136:139], v[112:115], v[120:123], v[136:139]
    s_cmp_lg_u32 s22, 0
    s_cbranch_scc1 L_s_poll_skip
    s_mov_b32 s55, 0
L_s_poll_flag_loop:
    global_load_dword v252, v250, s[20:21] sc1
    s_waitcnt vmcnt(0)
    v_readfirstlane_b32 s54, v252
    s_nop 0
    s_cmp_ge_u32 s54, 1
    s_cbranch_scc1 L_s_poll_flag_ok
    s_add_u32 s55, s55, 1
    s_cmp_ge_u32 s55, 0x40000
    s_cbranch_scc1 L_s_poll_flag_ok
    s_sleep 2
    s_branch L_s_poll_flag_loop
L_s_poll_flag_ok:
    v_lshlrev_b32 v172, 8, v4
    s_mov_b32 s55, 0
L_s_poll_loop:
    global_load_dword v252, v172, s[18:19] sc1
    s_waitcnt vmcnt(0)
    v_cmp_gt_u32 vcc, 16, v252
    s_nop 0
    s_cmp_eq_u64 vcc, 0
    s_cbranch_scc1 L_s_poll_skip
    s_add_u32 s55, s55, 1
    s_cmp_ge_u32 s55, 0x40000
    s_cbranch_scc1 L_s_poll_skip
    s_sleep 2
    s_branch L_s_poll_loop
L_s_poll_skip:
    s_waitcnt lgkmcnt(0)
    s_barrier
    s_lshl_b32 s52, s3, 5
    s_add_u32 s52, s52, 2097152
    s_add_u32 s53, s52, 16
    s_mov_b32 s54, s22
    s_lshl_b32 s50, s54, 6
    v_add_u32 v12, s50, v1
    v_mul_u32_u24 v13, 13108, v12
    v_lshrrev_b32 v13, 16, v13
    v_mul_u32_u24 v14, 5, v13
    v_sub_u32 v14, v12, v14
    v_min_u32 v14, 3, v14
    v_lshl_add_u32 v13, v13, 2, v14
    v_lshlrev_b32 v13, 13, v13
    s_lshl_b32 s50, s54, 10
    s_add_u32 s50, s50, 36352
    s_mov_b32 m0, s50
    s_nop 0
    buffer_load_dwordx4 v13, s[12:15], s52 offen sc1 lds
    s_add_u32 s50, s50, 8192
    s_mov_b32 m0, s50
    s_nop 0
    buffer_load_dwordx4 v13, s[12:15], s53 offen sc1 lds
    s_mov_b32 s54, 4
    s_lshl_b32 s50, s54, 6
    v_add_u32 v12, s50, v1
    v_mul_u32_u24 v13, 13108, v12
    v_lshrrev_b32 v13, 16, v13
    v_mul_u32_u24 v14, 5, v13
    v_sub_u32 v14, v12, v14
    v_min_u32 v14, 3, v14
    v_lshl_add_u32 v13, v13, 2, v14
    v_lshlrev_b32 v13, 13, v13
    s_lshl_b32 s50, s54, 10
    s_add_u32 s50, s50, 36352
    s_mov_b32 m0, s50
    s_nop 0
    buffer_load_dwordx4 v13, s[12:15], s52 offen sc1 lds
    s_add_u32 s50, s50, 8192
    s_mov_b32 m0, s50
    s_nop 0
    buffer_load_dwordx4 v13, s[12:15], s53 offen sc1 lds
    s_mul_i32 s50, s22, 3072
    s_add_u32 s50, s50, 49664
    v_lshlrev_b32 v45, 4, v1
    v_add_u32 v44, s50, v45
    ds_write_b128 v44, v[128:131] offset:0
    ds_write_b128 v44, v[132:135] offset:1024
    ds_write_b128 v44, v[136:139] offset:2048
    s_mul_i32 s50, s23, 6144
    s_lshl_b32 s51, s24, 3
    s_add_u32 s50, s50, s51
    s_add_u32 s50, s50, 49664
    v_add_u32 v46, s50, v45
    s_mul_i32 s50, s23, 3072
    s_add_u32 s50, s50, s51
    s_add_u32 s50, s50, 61952
    v_add_u32 v47, s50, v45
    v_mov_b32 v48, 0
    v_mov_b32 v49, 0
    v_mov_b32 v50, 0
    v_mov_b32 v51, 0
    s_min_u32 s50, s22, 2
    s_lshl_b32 s50, s50, 10
    s_add_u32 s50, s50, 33280
    v_add_u32 v52, s50, v45
    ds_write_b128 v52, v[48:51]
    ds_write_b128 v52, v[48:51] offset:8192
    s_waitcnt lgkmcnt(0)
    s_barrier
    ds_read_b64 v[64:65], v46 offset:0
    ds_read_b64 v[66:67], v46 offset:3072
    ds_read_b64 v[68:69], v46 offset:1024
    ds_read_b64 v[70:71], v46 offset:4096
    ds_read_b64 v[72:73], v46 offset:2048
    ds_read_b64 v[74:75], v46 offset:5120
    s_waitcnt lgkmcnt(4)
    v_add_f32 v64, v64, v66
    v_add_f32 v65, v65, v67
    ds_write_b64 v47, v[64:65] offset:0
    s_waitcnt lgkmcnt(2)
    v_add_f32 v68, v68, v70
    v_add_f32 v69, v69, v71
    ds_write_b64 v47, v[68:69] offset:1024
    s_waitcnt lgkmcnt(0)
    v_add_f32 v72, v72, v74
    v_add_f32 v73, v73, v75
    ds_write_b64 v47, v[72:73] offset:2048
    s_waitcnt lgkmcnt(0)
    s_barrier
    v_mov_b32 v88, 0
    v_mov_b32 v89, 0
    v_mov_b32 v90, 0
    v_mov_b32 v91, 0
    ds_read_b32 v64, v200 offset:0
    ds_read_b32 v65, v201 offset:0
    ds_read_b32 v66, v202 offset:0
    ds_read_b32 v67, v203 offset:0
    ds_read_b32 v68, v204 offset:0
    ds_read_b32 v69, v205 offset:0
    ds_read_b32 v70, v206 offset:0
    ds_read_b32 v71, v207 offset:0
    s_waitcnt lgkmcnt(0)
    v_cvt_pk_bf16_f32 v96, v64, v65
    v_cvt_pk_bf16_f32 v97, v66, v67
    v_cvt_pk_bf16_f32 v98, v68, v69
    v_cvt_pk_bf16_f32 v99, v70, v71
    ds_write_b128 v217, v[96:99]
    v_cmp_gt_u32 vcc, 4, v0
    s_nop 0
    s_and_saveexec_b64 s[50:51], vcc
    s_cbranch_execz L_nt0
    ds_write_b128 v217, v[88:91] offset:4096
L_nt0:
    s_mov_b64 exec, s[50:51]
    s_waitcnt lgkmcnt(0)
    s_barrier
    ds_read_b128 v[100:103], v217 offset:16
    s_waitcnt lgkmcnt(0)
    v_alignbit_b32 v64, v97, v96, 16
    v_alignbit_b32 v65, v98, v97, 16
    v_alignbit_b32 v66, v99, v98, 16
    v_alignbit_b32 v67, v100, v99, 16
    v_alignbit_b32 v68, v98, v97, 16
    v_alignbit_b32 v69, v99, v98, 16
    v_alignbit_b32 v70, v100, v99, 16
    v_alignbit_b32 v71, v101, v100, 16
    v_alignbit_b32 v72, v99, v98, 16
    v_alignbit_b32 v73, v100, v99, 16
    v_alignbit_b32 v74, v101, v100, 16
    v_alignbit_b32 v75, v102, v101, 16
    v_alignbit_b32 v76, v100, v99, 16
    v_alignbit_b32 v77, v101, v100, 16
    v_alignbit_b32 v78, v102, v101, 16
    v_alignbit_b32 v79, v103, v102, 16
    v_mov_b32 v80, v97
    v_mov_b32 v81, v98
    v_mov_b32 v82, v99
    v_mov_b32 v83, v100
    v_mov_b32 v84, v99
    v_mov_b32 v85, v100
    v_mov_b32 v86, v101
    v_mov_b32 v87, v102
    ds_write_b128 v216, v[96:99]
    ds_write_b128 v216, v[64:67] offset:4160
    ds_write_b128 v216, v[80:83] offset:8320
    ds_write_b128 v216, v[68:71] offset:12480
    ds_write_b128 v216, v[98:101] offset:16640
    ds_write_b128 v216, v[72:75] offset:20800
    ds_write_b128 v216, v[84:87] offset:24960
    ds_write_b128 v216, v[76:79] offset:29120
    v_cmp_gt_u32 vcc, 4, v0
    s_nop 0
    s_and_saveexec_b64 s[50:51], vcc
    s_cbranch_execz L_nt20
    ds_write_b128 v216, v[88:91] offset:4096
    ds_write_b128 v216, v[88:91] offset:8256
    ds_write_b128 v216, v[88:91] offset:12416
    ds_write_b128 v216, v[88:91] offset:16576
    ds_write_b128 v216, v[88:91] offset:20736
    ds_write_b128 v216, v[88:91] offset:24896
    ds_write_b128 v216, v[88:91] offset:29056
    ds_write_b128 v216, v[88:91] offset:33216
L_nt20:
    s_mov_b64 exec, s[50:51]
    s_waitcnt lgkmcnt(0)
    s_waitcnt vmcnt(0)
    s_barrier
    v_mov_b32 v32, 0
    v_mov_b32 v33, 0
    v_mov_b32 v34, 0
    v_mov_b32 v35, 0
    v_mov_b32 v36, 0
    v_mov_b32 v37, 0
    v_mov_b32 v38, 0
    v_mov_b32 v39, 0
    v_mov_b32 v40, 0
    v_mov_b32 v41, 0
    v_mov_b32 v42, 0
    v_mov_b32 v43, 0
    v_mov_b32 v44, 0
    v_mov_b32 v45, 0
    v_mov_b32 v46, 0
    v_mov_b32 v47, 0
    v_mov_b32 v48, 0
    v_mov_b32 v49, 0
    v_mov_b32 v50, 0
    v_mov_b32 v51, 0
    v_mov_b32 v52, 0
    v_mov_b32 v53, 0
    v_mov_b32 v54, 0
    v_mov_b32 v55, 0
    v_mov_b32 v56, 0
    v_mov_b32 v57, 0
    v_mov_b32 v58, 0
    v_mov_b32 v59, 0
    v_mov_b32 v60, 0
    v_mov_b32 v61, 0
    v_mov_b32 v62, 0
    v_mov_b32 v63, 0
    ds_read_b128 v[104:107], v208 offset:992
    ds_read_b128 v[108:111], v210 offset:1232
    ds_read_b128 v[112:115], v208 offset:960
    ds_read_b128 v[116:119], v210 offset:1200
    ds_read_b128 v[120:123], v208 offset:928
    ds_read_b128 v[124:127], v210 offset:1152
    ds_read_b128 v[128:131], v208 offset:896
    ds_read_b128 v[132:135], v210 offset:1120
    s_waitcnt lgkmcnt(6)
    v_mfma_f32_32x32x16_bf16 v[32:47], v[104:107], v[108:111], v[32:47]
    ds_read_b128 v[104:107], v208 offset:864
    ds_read_b128 v[108:111], v210 offset:1072
    s_waitcnt lgkmcnt(6)
    v_mfma_f32_32x32x16_bf16 v[32:47], v[112:115], v[116:119], v[32:47]
    ds_read_b128 v[112:115], v208 offset:832
    ds_read_b128 v[116:119], v210 offset:1040
    s_waitcnt lgkmcnt(6)
    v_mfma_f32_32x32x16_bf16 v[32:47], v[120:123], v[124:127], v[32:47]
    ds_read_b128 v[120:123], v208 offset:800
    ds_read_b128 v[124:127], v210 offset:992
    s_waitcnt lgkmcnt(6)
    v_mfma_f32_32x32x16_bf16 v[32:47], v[128:131], v[132:135], v[32:47]
    ds_read_b128 v[128:131], v208 offset:768
    ds_read_b128 v[132:135], v210 offset:960
    s_waitcnt lgkmcnt(6)
    v_mfma_f32_32x32x16_bf16 v[32:47], v[104:107], v[108:111], v[32:47]
    ds_read_b128 v[104:107], v208 offset:736
    ds_read_b128 v[108:111], v210 offset:912
    s_waitcnt lgkmcnt(6)
    v_mfma_f32_32x32x16_bf16 v[32:47], v[112:115], v[116:119], v[32:47]
    ds_read_b128 v[112:115], v208 offset:704
    ds_read_b128 v[116:119], v210 offset:880
    s_waitcnt lgkmcnt(6)
    v_mfma_f32_32x32x16_bf16 v[32:47], v[120:123], v[124:127], v[32:47]
    ds_read_b128 v[120:123], v208 offset:672
    ds_read_b128 v[124:127], v210 offset:832
    s_waitcnt lgkmcnt(6)
    v_mfma_f32_32x32x16_bf16 v[32:47], v[128:131], v[132:135], v[32:47]
    ds_read_b128 v[128:131], v208 offset:640
    ds_read_b128 v[132:135], v210 offset:800
    s_waitcnt lgkmcnt(6)
    v_mfma_f32_32x32x16_bf16 v[32:47], v[104:107], v[108:111], v[32:47]
    ds_read_b128 v[104:107], v208 offset:608
    ds_read_b128 v[108:111], v210 offset:752
    s_waitcnt lgkmcnt(6)
    v_mfma_f32_32x32x16_bf16 v[32:47], v[112:115], v[116:119], v[32:47]
    ds_read_b128 v[112:115], v208 offset:576
    ds_read_b128 v[116:119], v210 offset:720
    s_waitcnt lgkmcnt(6)
    v_mfma_f32_32x32x16_bf16 v[32:47], v[120:123], v[124:127], v[32:47]
    ds_read_b128 v[120:123], v208 offset:544
    ds_read_b128 v[124:127], v210 offset:672
    s_waitcnt lgkmcnt(6)
    v_mfma_f32_32x32x16_bf16 v[32:47], v[128:131], v[132:135], v[32:47]
    ds_read_b128 v[128:131], v208 offset:512
    ds_read_b128 v[132:135], v210 offset:640
    s_waitcnt lgkmcnt(6)
    v_mfma_f32_32x32x16_bf16 v[32:47], v[104:107], v[108:111], v[32:47]
    ds_read_b128 v[104:107], v208 offset:480
    ds_read_b128 v[108:111], v210 offset:592
    s_waitcnt lgkmcnt(6)
    v_mfma_f32_32x32x16_bf16 v[32:47], v[112:115], v[116:119], v[32:47]
    ds_read_b128 v[112:115], v208 offset:448
    ds_read_b128 v[116:119], v210 offset:560
    s_waitcnt lgkmcnt(6)
    v_mfma_f32_32x32x16_bf16 v[32:47], v[120:123], v[124:127], v[32:47]
    ds_read_b128 v[120:123], v208 offset:416
    ds_read_b128 v[124:127], v210 offset:512
    s_waitcnt lgkmcnt(6)
    v_mfma_f32_32x32x16_bf16 v[32:47], v[128:131], v[132:135], v[32:47]
    ds_read_b128 v[128:131], v208 offset:384
    ds_read_b128 v[132:135], v210 offset:480
    s_waitcnt lgkmcnt(6)
    v_mfma_f32_32x32x16_bf16 v[32:47], v[104:107], v[108:111], v[32:47]
    ds_read_b128 v[104:107], v208 offset:352
    ds_read_b128 v[108:111], v210 offset:432
    s_waitcnt lgkmcnt(6)
    v_mfma_f32_32x32x16_bf16 v[32:47], v[112:115], v[116:119], v[32:47]
    ds_read_b128 v[112:115], v208 offset:320
    ds_read_b128 v[116:119], v210 offset:400
    s_waitcnt lgkmcnt(6)
    v_mfma_f32_32x32x16_bf16 v[32:47], v[120:123], v[124:127], v[32:47]
    ds_read_b128 v[120:123], v208 offset:288
    ds_read_b128 v[124:127], v210 offset:352
    s_waitcnt lgkmcnt(6)
    v_mfma_f32_32x32x16_bf16 v[32:47], v[128:131], v[132:135], v[32:47]
    ds_read_b128 v[128:131], v208 offset:256
    ds_read_b128 v[132:135], v210 offset:320
    s_waitcnt lgkmcnt(6)
    v_mfma_f32_32x32x16_bf16 v[32:47], v[104:107], v[108:111], v[32:47]
    ds_read_b128 v[104:107], v208 offset:224
    ds_read_b128 v[108:111], v210 offset:272
    s_waitcnt lgkmcnt(6)
    v_mfma_f32_32x32x16_bf16 v[32:47], v[112:115], v[116:119], v[32:47]
    ds_read_b128 v[112:115], v208 offset:192
    ds_read_b128 v[116:119], v210 offset:240
    s_waitcnt lgkmcnt(6)
    v_mfma_f32_32x32x16_bf16 v[32:47], v[120:123], v[124:127], v[32:47]
    ds_read_b128 v[120:123], v208 offset:160
    ds_read_b128 v[124:127], v210 offset:192
    s_waitcnt lgkmcnt(6)
    v_mfma_f32_32x32x16_bf16 v[32:47], v[128:131], v[132:135], v[32:47]
    ds_read_b128 v[128:131], v208 offset:128
    ds_read_b128 v[132:135], v210 offset:160
    s_waitcnt lgkmcnt(6)
    v_mfma_f32_32x32x16_bf16 v[32:47], v[104:107], v[108:111], v[32:47]
    ds_read_b128 v[104:107], v208 offset:96
    ds_read_b128 v[108:111], v210 offset:112
    s_waitcnt lgkmcnt(6)
    v_mfma_f32_32x32x16_bf16 v[32:47], v[112:115], v[116:119], v[32:47]
    ds_read_b128 v[112:115], v208 offset:64
    ds_read_b128 v[116:119], v210 offset:80
    s_waitcnt lgkmcnt(6)
    v_mfma_f32_32x32x16_bf16 v[32:47], v[120:123], v[124:127], v[32:47]
    ds_read_b128 v[120:123], v208 offset:32
    ds_read_b128 v[124:127], v210 offset:32
    s_waitcnt lgkmcnt(6)
    v_mfma_f32_32x32x16_bf16 v[32:47], v[128:131], v[132:135], v[32:47]
    ds_read_b128 v[128:131], v208 offset:0
    ds_read_b128 v[132:135], v210 offset:0
    s_waitcnt lgkmcnt(6)
    v_mfma_f32_32x32x16_bf16 v[32:47], v[104:107], v[108:111], v[32:47]
    ds_read_b128 v[104:107], v209 offset:480
    ds_read_b128 v[108:111], v211 offset:592
    s_waitcnt lgkmcnt(6)
    v_mfma_f32_32x32x16_bf16 v[32:47], v[112:115], v[116:119], v[32:47]
    ds_read_b128 v[112:115], v209 offset:448
    ds_read_b128 v[116:119], v211 offset:560
    s_waitcnt lgkmcnt(6)
    v_mfma_f32_32x32x16_bf16 v[32:47], v[120:123], v[124:127], v[32:47]
    ds_read_b128 v[120:123], v209 offset:416
    ds_read_b128 v[124:127], v211 offset:512
    s_waitcnt lgkmcnt(6)
    v_mfma_f32_32x32x16_bf16 v[32:47], v[128:131], v[132:135], v[32:47]
    ds_read_b128 v[128:131], v209 offset:384
    ds_read_b128 v[132:135], v211 offset:480
    s_waitcnt lgkmcnt(6)
    v_mfma_f32_32x32x16_bf16 v[48:63], v[104:107], v[108:111], v[48:63]
    ds_read_b128 v[104:107], v209 offset:352
    ds_read_b128 v[108:111], v211 offset:432
    s_waitcnt lgkmcnt(6)
    v_mfma_f32_32x32x16_bf16 v[48:63], v[112:115], v[116:119], v[48:63]
    ds_read_b128 v[112:115], v209 offset:320
    ds_read_b128 v[116:119], v211 offset:400
    s_waitcnt lgkmcnt(6)
    v_mfma_f32_32x32x16_bf16 v[48:63], v[120:123], v[124:127], v[48:63]
    ds_read_b128 v[120:123], v209 offset:288
    ds_read_b128 v[124:127], v211 offset:352
    s_waitcnt lgkmcnt(6)
    v_mfma_f32_32x32x16_bf16 v[48:63], v[128:131], v[132:135], v[48:63]
    ds_read_b128 v[128:131], v209 offset:256
    ds_read_b128 v[132:135], v211 offset:320
    s_waitcnt lgkmcnt(6)
    v_mfma_f32_32x32x16_bf16 v[48:63], v[104:107], v[108:111], v[48:63]
    ds_read_b128 v[104:107], v209 offset:224
    ds_read_b128 v[108:111], v211 offset:272
    s_waitcnt lgkmcnt(6)
    v_mfma_f32_32x32x16_bf16 v[48:63], v[112:115], v[116:119], v[48:63]
    ds_read_b128 v[112:115], v209 offset:192
    ds_read_b128 v[116:119], v211 offset:240
    s_waitcnt lgkmcnt(6)
    v_mfma_f32_32x32x16_bf16 v[48:63], v[120:123], v[124:127], v[48:63]
    ds_read_b128 v[120:123], v209 offset:160
    ds_read_b128 v[124:127], v211 offset:192
    s_waitcnt lgkmcnt(6)
    v_mfma_f32_32x32x16_bf16 v[48:63], v[128:131], v[132:135], v[48:63]
    ds_read_b128 v[128:131], v209 offset:128
    ds_read_b128 v[132:135], v211 offset:160
    s_waitcnt lgkmcnt(6)
    v_mfma_f32_32x32x16_bf16 v[48:63], v[104:107], v[108:111], v[48:63]
    ds_read_b128 v[104:107], v209 offset:96
    ds_read_b128 v[108:111], v211 offset:112
    s_waitcnt lgkmcnt(6)
    v_mfma_f32_32x32x16_bf16 v[48:63], v[112:115], v[116:119], v[48:63]
    ds_read_b128 v[112:115], v209 offset:64
    ds_read_b128 v[116:119], v211 offset:80
    s_waitcnt lgkmcnt(6)
    v_mfma_f32_32x32x16_bf16 v[48:63], v[120:123], v[124:127], v[48:63]
    ds_read_b128 v[120:123], v209 offset:32
    ds_read_b128 v[124:127], v211 offset:32
    s_waitcnt lgkmcnt(6)
    v_mfma_f32_32x32x16_bf16 v[48:63], v[128:131], v[132:135], v[48:63]
    ds_read_b128 v[128:131], v209 offset:0
    ds_read_b128 v[132:135], v211 offset:0
    s_waitcnt lgkmcnt(6)
    v_mfma_f32_32x32x16_bf16 v[48:63], v[104:107], v[108:111], v[48:63]
    s_waitcnt lgkmcnt(4)
    v_mfma_f32_32x32x16_bf16 v[48:63], v[112:115], v[116:119], v[48:63]
    s_waitcnt lgkmcnt(2)
    v_mfma_f32_32x32x16_bf16 v[48:63], v[120:123], v[124:127], v[48:63]
    s_waitcnt lgkmcnt(0)
    v_mfma_f32_32x32x16_bf16 v[48:63], v[128:131], v[132:135], v[48:63]
    ds_read_b64 v[140:141], v212 offset:0
    ds_read_b64 v[142:143], v212 offset:16
    s_waitcnt lgkmcnt(0)
    s_barrier
    s_nop 7
    ds_write_b128 v214, v[48:51] offset:0
    ds_write_b128 v214, v[52:55] offset:1024
    ds_write_b128 v214, v[56:59] offset:2048
    ds_write_b128 v214, v[60:63] offset:3072
    ds_write_b128 v214, v[32:35] offset:4096
    ds_write_b128 v214, v[36:39] offset:5120
    ds_write_b128 v214, v[40:43] offset:6144
    ds_write_b128 v214, v[44:47] offset:7168
    s_waitcnt lgkmcnt(0)
    s_barrier
    ds_read_b128 v[104:107], v215 offset:0
    ds_read_b128 v[108:111], v215 offset:1024
    ds_read_b128 v[112:115], v215 offset:8192
    ds_read_b128 v[116:119], v215 offset:9216
    ds_read_b128 v[120:123], v215 offset:16384
    ds_read_b128 v[124:127], v215 offset:17408
    ds_read_b128 v[128:131], v215 offset:24576
    ds_read_b128 v[132:135], v215 offset:25600
    s_waitcnt lgkmcnt(0)
    v_add_f32 v104, v104, v112
    v_add_f32 v120, v120, v128
    v_add_f32 v104, v104, v120
    v_add_f32 v105, v105, v113
    v_add_f32 v121, v121, v129
    v_add_f32 v105, v105, v121
    v_add_f32 v106, v106, v114
    v_add_f32 v122, v122, v130
    v_add_f32 v106, v106, v122
    v_add_f32 v107, v107, v115
    v_add_f32 v123, v123, v131
    v_add_f32 v107, v107, v123
    v_add_f32 v108, v108, v116
    v_add_f32 v124, v124, v132
    v_add_f32 v108, v108, v124
    v_add_f32 v109, v109, v117
    v_add_f32 v125, v125, v133
    v_add_f32 v109, v109, v125
    v_add_f32 v110, v110, v118
    v_add_f32 v126, v126, v134
    v_add_f32 v110, v110, v126
    v_add_f32 v111, v111, v119
    v_add_f32 v127, v127, v135
    v_add_f32 v111, v111, v127
    v_lshlrev_b32 v144, 16, v140
    v_and_b32 v145, 0xffff0000, v140
    v_mul_f32 v144, s34, v144
    v_mul_f32 v145, s34, v145
    v_cvt_pk_bf16_f32 v146, v144, v145
    v_lshlrev_b32 v144, 16, v146
    v_and_b32 v145, 0xffff0000, v146
    v_cvt_pk_bf16_f32 v146, v104, v105
    v_lshlrev_b32 v104, 16, v146
    v_and_b32 v105, 0xffff0000, v146
    v_add_f32 v104, v104, v144
    v_add_f32 v105, v105, v145
    v_cvt_pk_bf16_f32 v148, v104, v105
    v_lshlrev_b32 v144, 16, v141
    v_and_b32 v145, 0xffff0000, v141
    v_mul_f32 v144, s34, v144
    v_mul_f32 v145, s34, v145
    v_cvt_pk_bf16_f32 v146, v144, v145
    v_lshlrev_b32 v144, 16, v146
    v_and_b32 v145, 0xffff0000, v146
    v_cvt_pk_bf16_f32 v146, v106, v107
    v_lshlrev_b32 v106, 16, v146
    v_and_b32 v107, 0xffff0000, v146
    v_add_f32 v106, v106, v144
    v_add_f32 v107, v107, v145
    v_cvt_pk_bf16_f32 v149, v106, v107
    v_lshlrev_b32 v144, 16, v142
    v_and_b32 v145, 0xffff0000, v142
    v_mul_f32 v144, s34, v144
    v_mul_f32 v145, s34, v145
    v_cvt_pk_bf16_f32 v146, v144, v145
    v_lshlrev_b32 v144, 16, v146
    v_and_b32 v145, 0xffff0000, v146
    v_cvt_pk_bf16_f32 v146, v108, v109
    v_lshlrev_b32 v108, 16, v146
    v_and_b32 v109, 0xffff0000, v146
    v_add_f32 v108, v108, v144
    v_add_f32 v109, v109, v145
    v_cvt_pk_bf16_f32 v150, v108, v109
    v_lshlrev_b32 v144, 16, v143
    v_and_b32 v145, 0xffff0000, v143
    v_mul_f32 v144, s34, v144
    v_mul_f32 v145, s34, v145
    v_cvt_pk_bf16_f32 v146, v144, v145
    v_lshlrev_b32 v144, 16, v146
    v_and_b32 v145, 0xffff0000, v146
    v_cvt_pk_bf16_f32 v146, v110, v111
    v_lshlrev_b32 v110, 16, v146
    v_and_b32 v111, 0xffff0000, v146
    v_add_f32 v110, v110, v144
    v_add_f32 v111, v111, v145
    v_cvt_pk_bf16_f32 v151, v110, v111
    v_permlane32_swap_b32 v148, v150
    s_nop 0
    v_permlane32_swap_b32 v149, v151
    global_store_dwordx4 v213, v[148:151], s[4:5] sc1
    ds_read_b32 v64, v200 offset:3072
    ds_read_b32 v65, v201 offset:3072
    ds_read_b32 v66, v202 offset:3072
    ds_read_b32 v67, v203 offset:3072
    ds_read_b32 v68, v204 offset:3072
    ds_read_b32 v69, v205 offset:3072
    ds_read_b32 v70, v206 offset:3072
    ds_read_b32 v71, v207 offset:3072
    s_waitcnt lgkmcnt(0)
    v_cvt_pk_bf16_f32 v96, v64, v65
    v_cvt_pk_bf16_f32 v97, v66, v67
    v_cvt_pk_bf16_f32 v98, v68, v69
    v_cvt_pk_bf16_f32 v99, v70, v71
    ds_write_b128 v217, v[96:99]
    v_cmp_gt_u32 vcc, 4, v0
    s_nop 0
    s_and_saveexec_b64 s[50:51], vcc
    s_cbranch_execz L_nt1
    ds_write_b128 v217, v[88:91] offset:4096
L_nt1:
    s_mov_b64 exec, s[50:51]
    s_waitcnt lgkmcnt(0)
    s_barrier
    ds_read_b128 v[100:103], v217 offset:16
    s_waitcnt lgkmcnt(0)
    v_alignbit_b32 v64, v97, v96, 16
    v_alignbit_b32 v65, v98, v97, 16
    v_alignbit_b32 v66, v99, v98, 16
    v_alignbit_b32 v67, v100, v99, 16
    v_alignbit_b32 v68, v98, v97, 16
    v_alignbit_b32 v69, v99, v98, 16
    v_alignbit_b32 v70, v100, v99, 16
    v_alignbit_b32 v71, v101, v100, 16
    v_alignbit_b32 v72, v99, v98, 16
    v_alignbit_b32 v73, v100, v99, 16
    v_alignbit_b32 v74, v101, v100, 16
    v_alignbit_b32 v75, v102, v101, 16
    v_alignbit_b32 v76, v100, v99, 16
    v_alignbit_b32 v77, v101, v100, 16
    v_alignbit_b32 v78, v102, v101, 16
    v_alignbit_b32 v79, v103, v102, 16
    v_mov_b32 v80, v97
    v_mov_b32 v81, v98
    v_mov_b32 v82, v99
    v_mov_b32 v83, v100
    v_mov_b32 v84, v99
    v_mov_b32 v85, v100
    v_mov_b32 v86, v101
    v_mov_b32 v87, v102
    ds_write_b128 v216, v[96:99]
    ds_write_b128 v216, v[64:67] offset:4160
    ds_write_b128 v216, v[80:83] offset:8320
    ds_write_b128 v216, v[68:71] offset:12480
    ds_write_b128 v216, v[98:101] offset:16640
    ds_write_b128 v216, v[72:75] offset:20800
    ds_write_b128 v216, v[84:87] offset:24960
    ds_write_b128 v216, v[76:79] offset:29120
    v_cmp_gt_u32 vcc, 4, v0
    s_nop 0
    s_and_saveexec_b64 s[50:51], vcc
    s_cbranch_execz L_nt21
    ds_write_b128 v216, v[88:91] offset:4096
    ds_write_b128 v216, v[88:91] offset:8256
    ds_write_b128 v216, v[88:91] offset:12416
    ds_write_b128 v216, v[88:91] offset:16576
    ds_write_b128 v216, v[88:91] offset:20736
    ds_write_b128 v216, v[88:91] offset:24896
    ds_write_b128 v216, v[88:91] offset:29056
    ds_write_b128 v216, v[88:91] offset:33216
L_nt21:
    s_mov_b64 exec, s[50:51]
    s_waitcnt lgkmcnt(0)
    s_barrier
    v_mov_b32 v32, 0
    v_mov_b32 v33, 0
    v_mov_b32 v34, 0
    v_mov_b32 v35, 0
    v_mov_b32 v36, 0
    v_mov_b32 v37, 0
    v_mov_b32 v38, 0
    v_mov_b32 v39, 0
    v_mov_b32 v40, 0
    v_mov_b32 v41, 0
    v_mov_b32 v42, 0
    v_mov_b32 v43, 0
    v_mov_b32 v44, 0
    v_mov_b32 v45, 0
    v_mov_b32 v46, 0
    v_mov_b32 v47, 0
    v_mov_b32 v48, 0
    v_mov_b32 v49, 0
    v_mov_b32 v50, 0
    v_mov_b32 v51, 0
    v_mov_b32 v52, 0
    v_mov_b32 v53, 0
    v_mov_b32 v54, 0
    v_mov_b32 v55, 0
    v_mov_b32 v56, 0
    v_mov_b32 v57, 0
    v_mov_b32 v58, 0
    v_mov_b32 v59, 0
    v_mov_b32 v60, 0
    v_mov_b32 v61, 0
    v_mov_b32 v62, 0
    v_mov_b32 v63, 0
    ds_read_b128 v[104:107], v208 offset:992
    ds_read_b128 v[108:111], v210 offset:9424
    ds_read_b128 v[112:115], v208 offset:960
    ds_read_b128 v[116:119], v210 offset:9392
    ds_read_b128 v[120:123], v208 offset:928
    ds_read_b128 v[124:127], v210 offset:9344
    ds_read_b128 v[128:131], v208 offset:896
    ds_read_b128 v[132:135], v210 offset:9312
    s_waitcnt lgkmcnt(6)
    v_mfma_f32_32x32x16_bf16 v[32:47], v[104:107], v[108:111], v[32:47]
    ds_read_b128 v[104:107], v208 offset:864
    ds_read_b128 v[108:111], v210 offset:9264
    s_waitcnt lgkmcnt(6)
    v_mfma_f32_32x32x16_bf16 v[32:47], v[112:115], v[116:119], v[32:47]
    ds_read_b128 v[112:115], v208 offset:832
    ds_read_b128 v[116:119], v210 offset:9232
    s_waitcnt lgkmcnt(6)
    v_mfma_f32_32x32x16_bf16 v[32:47], v[120:123], v[124:127], v[32:47]
    ds_read_b128 v[120:123], v208 offset:800
    ds_read_b128 v[124:127], v210 offset:9184
    s_waitcnt lgkmcnt(6)
    v_mfma_f32_32x32x16_bf16 v[32:47], v[128:131], v[132:135], v[32:47]
    ds_read_b128 v[128:131], v208 offset:768
    ds_read_b128 v[132:135], v210 offset:9152
    s_waitcnt lgkmcnt(6)
    v_mfma_f32_32x32x16_bf16 v[32:47], v[104:107], v[108:111], v[32:47]
    ds_read_b128 v[104:107], v208 offset:736
    ds_read_b128 v[108:111], v210 offset:9104
    s_waitcnt lgkmcnt(6)
    v_mfma_f32_32x32x16_bf16 v[32:47], v[112:115], v[116:119], v[32:47]
    ds_read_b128 v[112:115], v208 offset:704
    ds_read_b128 v[116:119], v210 offset:9072
    s_waitcnt lgkmcnt(6)
    v_mfma_f32_32x32x16_bf16 v[32:47], v[120:123], v[124:127], v[32:47]
    ds_read_b128 v[120:123], v208 offset:672
    ds_read_b128 v[124:127], v210 offset:9024
    s_waitcnt lgkmcnt(6)
    v_mfma_f32_32x32x16_bf16 v[32:47], v[128:131], v[132:135], v[32:47]
    ds_read_b128 v[128:131], v208 offset:640
    ds_read_b128 v[132:135], v210 offset:8992
    s_waitcnt lgkmcnt(6)
    v_mfma_f32_32x32x16_bf16 v[32:47], v[104:107], v[108:111], v[32:47]
    ds_read_b128 v[104:107], v208 offset:608
    ds_read_b128 v[108:111], v210 offset:8944
    s_waitcnt lgkmcnt(6)
    v_mfma_f32_32x32x16_bf16 v[32:47], v[112:115], v[116:119], v[32:47]
    ds_read_b128 v[112:115], v208 offset:576
    ds_read_b128 v[116:119], v210 offset:8912
    s_waitcnt lgkmcnt(6)
    v_mfma_f32_32x32x16_bf16 v[32:47], v[120:123], v[124:127], v[32:47]
    ds_read_b128 v[120:123], v208 offset:544
    ds_read_b128 v[124:127], v210 offset:8864
    s_waitcnt lgkmcnt(6)
    v_mfma_f32_32x32x16_bf16 v[32:47], v[128:131], v[132:135], v[32:47]
    ds_read_b128 v[128:131], v208 offset:512
    ds_read_b128 v[132:135], v210 offset:8832
    s_waitcnt lgkmcnt(6)
    v_mfma_f32_32x32x16_bf16 v[32:47], v[104:107], v[108:111], v[32:47]
    ds_read_b128 v[104:107], v208 offset:480
    ds_read_b128 v[108:111], v210 offset:8784
    s_waitcnt lgkmcnt(6)
    v_mfma_f32_32x32x16_bf16 v[32:47], v[112:115], v[116:119], v[32:47]
    ds_read_b128 v[112:115], v208 offset:448
    ds_read_b128 v[116:119], v210 offset:8752
    s_waitcnt lgkmcnt(6)
    v_mfma_f32_32x32x16_bf16 v[32:47], v[120:123], v[124:127], v[32:47]
    ds_read_b128 v[120:123], v208 offset:416
    ds_read_b128 v[124:127], v210 offset:8704
    s_waitcnt lgkmcnt(6)
    v_mfma_f32_32x32x16_bf16 v[32:47], v[128:131], v[132:135], v[32:47]
    ds_read_b128 v[128:131], v208 offset:384
    ds_read_b128 v[132:135], v210 offset:8672
    s_waitcnt lgkmcnt(6)
    v_mfma_f32_32x32x16_bf16 v[32:47], v[104:107], v[108:111], v[32:47]
    ds_read_b128 v[104:107], v208 offset:352
    ds_read_b128 v[108:111], v210 offset:8624
    s_waitcnt lgkmcnt(6)
    v_mfma_f32_32x32x16_bf16 v[32:47], v[112:115], v[116:119], v[32:47]
    ds_read_b128 v[112:115], v208 offset:320
    ds_read_b128 v[116:119], v210 offset:8592
    s_waitcnt lgkmcnt(6)
    v_mfma_f32_32x32x16_bf16 v[32:47], v[120:123], v[124:127], v[32:47]
    ds_read_b128 v[120:123], v208 offset:288
    ds_read_b128 v[124:127], v210 offset:8544
    s_waitcnt lgkmcnt(6)
    v_mfma_f32_32x32x16_bf16 v[32:47], v[128:131], v[132:135], v[32:47]
    ds_read_b128 v[128:131], v208 offset:256
    ds_read_b128 v[132:135], v210 offset:8512
    s_waitcnt lgkmcnt(6)
    v_mfma_f32_32x32x16_bf16 v[32:47], v[104:107], v[108:111], v[32:47]
    ds_read_b128 v[104:107], v208 offset:224
    ds_read_b128 v[108:111], v210 offset:8464
    s_waitcnt lgkmcnt(6)
    v_mfma_f32_32x32x16_bf16 v[32:47], v[112:115], v[116:119], v[32:47]
    ds_read_b128 v[112:115], v208 offset:192
    ds_read_b128 v[116:119], v210 offset:8432
    s_waitcnt lgkmcnt(6)
    v_mfma_f32_32x32x16_bf16 v[32:47], v[120:123], v[124:127], v[32:47]
    ds_read_b128 v[120:123], v208 offset:160
    ds_read_b128 v[124:127], v210 offset:8384
    s_waitcnt lgkmcnt(6)
    v_mfma_f32_32x32x16_bf16 v[32:47], v[128:131], v[132:135], v[32:47]
    ds_read_b128 v[128:131], v208 offset:128
    ds_read_b128 v[132:135], v210 offset:8352
    s_waitcnt lgkmcnt(6)
    v_mfma_f32_32x32x16_bf16 v[32:47], v[104:107], v[108:111], v[32:47]
    ds_read_b128 v[104:107], v208 offset:96
    ds_read_b128 v[108:111], v210 offset:8304
    s_waitcnt lgkmcnt(6)
    v_mfma_f32_32x32x16_bf16 v[32:47], v[112:115], v[116:119], v[32:47]
    ds_read_b128 v[112:115], v208 offset:64
    ds_read_b128 v[116:119], v210 offset:8272
    s_waitcnt lgkmcnt(6)
    v_mfma_f32_32x32x16_bf16 v[32:47], v[120:123], v[124:127], v[32:47]
    ds_read_b128 v[120:123], v208 offset:32
    ds_read_b128 v[124:127], v210 offset:8224
    s_waitcnt lgkmcnt(6)
    v_mfma_f32_32x32x16_bf16 v[32:47], v[128:131], v[132:135], v[32:47]
    ds_read_b128 v[128:131], v208 offset:0
    ds_read_b128 v[132:135], v210 offset:8192
    s_waitcnt lgkmcnt(6)
    v_mfma_f32_32x32x16_bf16 v[32:47], v[104:107], v[108:111], v[32:47]
    ds_read_b128 v[104:107], v209 offset:480
    ds_read_b128 v[108:111], v211 offset:8784
    s_waitcnt lgkmcnt(6)
    v_mfma_f32_32x32x16_bf16 v[32:47], v[112:115], v[116:119], v[32:47]
    ds_read_b128 v[112:115], v209 offset:448
    ds_read_b128 v[116:119], v211 offset:8752
    s_waitcnt lgkmcnt(6)
    v_mfma_f32_32x32x16_bf16 v[32:47], v[120:123], v[124:127], v[32:47]
    ds_read_b128 v[120:123], v209 offset:416
    ds_read_b128 v[124:127], v211 offset:8704
    s_waitcnt lgkmcnt(6)
    v_mfma_f32_32x32x16_bf16 v[32:47], v[128:131], v[132:135], v[32:47]
    ds_read_b128 v[128:131], v209 offset:384
    ds_read_b128 v[132:135], v211 offset:8672
    s_waitcnt lgkmcnt(6)
    v_mfma_f32_32x32x16_bf16 v[48:63], v[104:107], v[108:111], v[48:63]
    ds_read_b128 v[104:107], v209 offset:352
    ds_read_b128 v[108:111], v211 offset:8624
    s_waitcnt lgkmcnt(6)
    v_mfma_f32_32x32x16_bf16 v[48:63], v[112:115], v[116:119], v[48:63]
    ds_read_b128 v[112:115], v209 offset:320
    ds_read_b128 v[116:119], v211 offset:8592
    s_waitcnt lgkmcnt(6)
    v_mfma_f32_32x32x16_bf16 v[48:63], v[120:123], v[124:127], v[48:63]
    ds_read_b128 v[120:123], v209 offset:288
    ds_read_b128 v[124:127], v211 offset:8544
    s_waitcnt lgkmcnt(6)
    v_mfma_f32_32x32x16_bf16 v[48:63], v[128:131], v[132:135], v[48:63]
    ds_read_b128 v[128:131], v209 offset:256
    ds_read_b128 v[132:135], v211 offset:8512
    s_waitcnt lgkmcnt(6)
    v_mfma_f32_32x32x16_bf16 v[48:63], v[104:107], v[108:111], v[48:63]
    ds_read_b128 v[104:107], v209 offset:224
    ds_read_b128 v[108:111], v211 offset:8464
    s_waitcnt lgkmcnt(6)
    v_mfma_f32_32x32x16_bf16 v[48:63], v[112:115], v[116:119], v[48:63]
    ds_read_b128 v[112:115], v209 offset:192
    ds_read_b128 v[116:119], v211 offset:8432
    s_waitcnt lgkmcnt(6)
    v_mfma_f32_32x32x16_bf16 v[48:63], v[120:123], v[124:127], v[48:63]
    ds_read_b128 v[120:123], v209 offset:160
    ds_read_b128 v[124:127], v211 offset:8384
    s_waitcnt lgkmcnt(6)
    v_mfma_f32_32x32x16_bf16 v[48:63], v[128:131], v[132:135], v[48:63]
    ds_read_b128 v[128:131], v209 offset:128
    ds_read_b128 v[132:135], v211 offset:8352
    s_waitcnt lgkmcnt(6)
    v_mfma_f32_32x32x16_bf16 v[48:63], v[104:107], v[108:111], v[48:63]
    ds_read_b128 v[104:107], v209 offset:96
    ds_read_b128 v[108:111], v211 offset:8304
    s_waitcnt lgkmcnt(6)
    v_mfma_f32_32x32x16_bf16 v[48:63], v[112:115], v[116:119], v[48:63]
    ds_read_b128 v[112:115], v209 offset:64
    ds_read_b128 v[116:119], v211 offset:8272
    s_waitcnt lgkmcnt(6)
    v_mfma_f32_32x32x16_bf16 v[48:63], v[120:123], v[124:127], v[48:63]
    ds_read_b128 v[120:123], v209 offset:32
    ds_read_b128 v[124:127], v211 offset:8224
    s_waitcnt lgkmcnt(6)
    v_mfma_f32_32x32x16_bf16 v[48:63], v[128:131], v[132:135], v[48:63]
    ds_read_b128 v[128:131], v209 offset:0
    ds_read_b128 v[132:135], v211 offset:8192
    s_waitcnt lgkmcnt(6)
    v_mfma_f32_32x32x16_bf16 v[48:63], v[104:107], v[108:111], v[48:63]
    s_waitcnt lgkmcnt(4)
    v_mfma_f32_32x32x16_bf16 v[48:63], v[112:115], v[116:119], v[48:63]
    s_waitcnt lgkmcnt(2)
    v_mfma_f32_32x32x16_bf16 v[48:63], v[120:123], v[124:127], v[48:63]
    s_waitcnt lgkmcnt(0)
    v_mfma_f32_32x32x16_bf16 v[48:63], v[128:131], v[132:135], v[48:63]
    ds_read_b64 v[140:141], v212 offset:8192
    ds_read_b64 v[142:143], v212 offset:8208
    s_waitcnt lgkmcnt(0)
    s_barrier
    s_nop 7
    ds_write_b128 v214, v[48:51] offset:0
    ds_write_b128 v214, v[52:55] offset:1024
    ds_write_b128 v214, v[56:59] offset:2048
    ds_write_b128 v214, v[60:63] offset:3072
    ds_write_b128 v214, v[32:35] offset:4096
    ds_write_b128 v214, v[36:39] offset:5120
    ds_write_b128 v214, v[40:43] offset:6144
    ds_write_b128 v214, v[44:47] offset:7168
    s_waitcnt lgkmcnt(0)
    s_barrier
    ds_read_b128 v[104:107], v215 offset:0
    ds_read_b128 v[108:111], v215 offset:1024
    ds_read_b128 v[112:115], v215 offset:8192
    ds_read_b128 v[116:119], v215 offset:9216
    ds_read_b128 v[120:123], v215 offset:16384
    ds_read_b128 v[124:127], v215 offset:17408
    ds_read_b128 v[128:131], v215 offset:24576
    ds_read_b128 v[132:135], v215 offset:25600
    s_waitcnt lgkmcnt(0)
    v_add_f32 v104, v104, v112
    v_add_f32 v120, v120, v128
    v_add_f32 v104, v104, v120
    v_add_f32 v105, v105, v113
    v_add_f32 v121, v121, v129
    v_add_f32 v105, v105, v121
    v_add_f32 v106, v106, v114
    v_add_f32 v122, v122, v130
    v_add_f32 v106, v106, v122
    v_add_f32 v107, v107, v115
    v_add_f32 v123, v123, v131
    v_add_f32 v107, v107, v123
    v_add_f32 v108, v108, v116
    v_add_f32 v124, v124, v132
    v_add_f32 v108, v108, v124
    v_add_f32 v109, v109, v117
    v_add_f32 v125, v125, v133
    v_add_f32 v109, v109, v125
    v_add_f32 v110, v110, v118
    v_add_f32 v126, v126, v134
    v_add_f32 v110, v110, v126
    v_add_f32 v111, v111, v119
    v_add_f32 v127, v127, v135
    v_add_f32 v111, v111, v127
    v_lshlrev_b32 v144, 16, v140
    v_and_b32 v145, 0xffff0000, v140
    v_mul_f32 v144, s35, v144
    v_mul_f32 v145, s35, v145
    v_cvt_pk_bf16_f32 v146, v144, v145
    v_lshlrev_b32 v144, 16, v146
    v_and_b32 v145, 0xffff0000, v146
    v_cvt_pk_bf16_f32 v146, v104, v105
    v_lshlrev_b32 v104, 16, v146
    v_and_b32 v105, 0xffff0000, v146
    v_add_f32 v104, v104, v144
    v_add_f32 v105, v105, v145
    v_cvt_pk_bf16_f32 v148, v104, v105
    v_lshlrev_b32 v144, 16, v141
    v_and_b32 v145, 0xffff0000, v141
    v_mul_f32 v144, s35, v144
    v_mul_f32 v145, s35, v145
    v_cvt_pk_bf16_f32 v146, v144, v145
    v_lshlrev_b32 v144, 16, v146
    v_and_b32 v145, 0xffff0000, v146
    v_cvt_pk_bf16_f32 v146, v106, v107
    v_lshlrev_b32 v106, 16, v146
    v_and_b32 v107, 0xffff0000, v146
    v_add_f32 v106, v106, v144
    v_add_f32 v107, v107, v145
    v_cvt_pk_bf16_f32 v149, v106, v107
    v_lshlrev_b32 v144, 16, v142
    v_and_b32 v145, 0xffff0000, v142
    v_mul_f32 v144, s35, v144
    v_mul_f32 v145, s35, v145
    v_cvt_pk_bf16_f32 v146, v144, v145
    v_lshlrev_b32 v144, 16, v146
    v_and_b32 v145, 0xffff0000, v146
    v_cvt_pk_bf16_f32 v146, v108, v109
    v_lshlrev_b32 v108, 16, v146
    v_and_b32 v109, 0xffff0000, v146
    v_add_f32 v108, v108, v144
    v_add_f32 v109, v109, v145
    v_cvt_pk_bf16_f32 v150, v108, v109
    v_lshlrev_b32 v144, 16, v143
    v_and_b32 v145, 0xffff0000, v143
    v_mul_f32 v144, s35, v144
    v_mul_f32 v145, s35, v145
    v_cvt_pk_bf16_f32 v146, v144, v145
    v_lshlrev_b32 v144, 16, v146
    v_and_b32 v145, 0xffff0000, v146
    v_cvt_pk_bf16_f32 v146, v110, v111
    v_lshlrev_b32 v110, 16, v146
    v_and_b32 v111, 0xffff0000, v146
    v_add_f32 v110, v110, v144
    v_add_f32 v111, v111, v145
    v_cvt_pk_bf16_f32 v151, v110, v111
    v_permlane32_swap_b32 v148, v150
    s_nop 0
    v_permlane32_swap_b32 v149, v151
    v_add_u32 v213, 0x1000, v213
    global_store_dwordx4 v213, v[148:151], s[4:5] sc1
    s_waitcnt vmcnt(0)
    s_barrier
    s_cmp_lg_u32 s22, 0
    s_cbranch_scc1 L_sig_a
    s_lshr_b32 s50, s3, 5
    s_add_u32 s50, s50, 32
    s_lshl_b32 s50, s50, 8
    s_add_u32 s50, s18, s50
    s_addc_u32 s51, s19, 0
    s_mov_b64 exec, 1
    global_atomic_add v250, v251, s[50:51]
    s_mov_b64 exec, -1
L_sig_a:
L_done:
    s_endpgm
.section .rodata,"a"
.p2align 6
.amdhsa_kernel parallel_sum__ssm_conv_s4__dense_activation_mish__prompt_kernel
  .amdhsa_next_free_vgpr 256
  .amdhsa_next_free_sgpr 102
  .amdhsa_accum_offset 256
  .amdhsa_group_segment_fixed_size 0
  .amdhsa_kernarg_size 128
  .amdhsa_user_sgpr_count 2
  .amdhsa_user_sgpr_kernarg_segment_ptr 1
  .amdhsa_system_sgpr_workgroup_id_x 1
.end_amdhsa_kernel
```
